```python
import torch

def _softmax(x, axis=-1):
    return torch.softmax(x, dim=axis)

def _gelu(x):
    return torch.nn.functional.gelu(x, approximate='tanh')

def _silu(x):
    return torch.nn.functional.silu(x)

def _sigmoid(x):
    return torch.sigmoid(x)

def _layernorm(x, axis=-1, eps=1e-05):
    m = x.mean(dim=axis, keepdim=True)
    v = x.var(dim=axis, keepdim=True, unbiased=False)
    return (x - m) / torch.sqrt(v + eps)

def _scatter_add(tgt, idx, src, axis=0):
    return tgt.clone().index_add_(axis, idx, src)

def _segment_sum(src, seg, n):
    out = torch.zeros((n,) + src.shape[1:], dtype=src.dtype)
    return out.index_add_(0, seg, src)

def _pad(x, pw):
    flat = tuple((v for pair in reversed(pw) for v in pair))
    return torch.nn.functional.pad(x, flat)
kernel_name = 'adaLN_cond__sliding_local_dilated__dense_activation_silu__prompt'

def setup_inputs():

    _w = lambda a: (lambda t: t.to(torch.bfloat16) if t.is_floating_point() else t)(torch.as_tensor(a))

    def _A_setup():
        B, S, D = (1, 2048, 448)
        return {'x': _w((lambda *s: torch.randn(*s, dtype=torch.bfloat16) * 0.05)(B, S, D)), 'wqkv': _w((lambda *s: torch.randn(*s, dtype=torch.bfloat16) * 0.05)(D, 3 * D)), 'wo': _w((lambda *s: torch.randn(*s, dtype=torch.bfloat16) * 0.05)(D, D))}
    _A_in = _A_setup()

    def _B_setup():
        B, S, D, F = (1, 2048, 448, 1792)
        return {'x': _w((lambda *s: torch.randn(*s, dtype=torch.bfloat16) * 0.05)(B, S, D)), 'w1': _w((lambda *s: torch.randn(*s, dtype=torch.bfloat16) * 3.2)(D, F) * D ** (-0.5)), 'w2': _w((lambda *s: torch.randn(*s, dtype=torch.bfloat16) * 0.4)(F, D) * F ** (-0.5))}
    _B_in = _B_setup()
    return {'A_x': _A_in['x'], 'A_wqkv': _A_in['wqkv'], 'A_wo': _A_in['wo'], 'B_x': _B_in['x'], 'B_w1': _B_in['w1'], 'B_w2': _B_in['w2'], 'c': _w((lambda *s: torch.randn(*s, dtype=torch.bfloat16) * 0.1)(1, 448) * 8.0), 'w_mod': _w((lambda *s: torch.randn(*s, dtype=torch.bfloat16) * 0.1)(448, 6 * 448) * 448 ** (-0.5) * 8.0)}

def reference(A_x, A_wqkv, A_wo, B_x, B_w1, B_w2, c, w_mod):

    def _A_ref(x, wqkv, wo):
        B, S, D = x.shape
        H = 16
        Dh = D // H
        W, dil = (8, 2)
        qkv = (lambda x, *d: x.permute(*d))((x @ wqkv).reshape(B, S, 3, H, Dh), 2, 0, 3, 1, 4)
        q, k, v = (qkv[0], qkv[1], qkv[2])
        scale = Dh ** (-0.5)
        pos = torch.arange(S)
        off = torch.arange(W) * dil
        idx = pos[:, None] - off[None, :]
        mask = idx >= 0
        idx_c = torch.where(mask, idx, 0).reshape(-1)
        kg = k[:, :, idx_c, :].reshape(B, H, S, W, Dh)
        vg = v[:, :, idx_c, :].reshape(B, H, S, W, Dh)
        logits = torch.einsum('bhsd,bhswd->bhsw', q, kg) * scale
        logits = torch.where(mask[None, None, :, :], logits, -1000000000.0)
        attn = _softmax(logits, axis=-1)
        o = torch.einsum('bhsw,bhswd->bhsd', attn, vg)
        return (lambda x, *d: x.permute(*d))(o, 0, 2, 1, 3).reshape(B, S, D) @ wo

    def _B_ref(x, w1, w2):
        h = torch.einsum('bsd,df->bsf', x, w1)
        h = _silu(h)
        out = torch.einsum('bsf,fd->bsd', h, w2)
        return out
    x = A_x
    mod = (_silu(c) @ w_mod).reshape(c.shape[0], 6, 1, -1)
    sa, ca, ga, sb, cb, gb = (mod[:, 0].clone(), mod[:, 1].clone(), mod[:, 2].clone(), mod[:, 3].clone(), mod[:, 4].clone(), mod[:, 5].clone())
    h = _layernorm(x, axis=-1) * (1 + ca) + sa
    x = x + ga * _A_ref(h, A_wqkv, A_wo)
    h = _layernorm(x, axis=-1) * (1 + cb) + sb
    x = x + gb * _B_ref(h, B_w1, B_w2)
    return x
```

```asm
; @launch grid=(256,1,1) block=(256,1,1) lds=163840
.amdgcn_target "amdgcn-amd-amdhsa--gfx950"
.text
.globl adaLN_cond__sliding_local_dilated__dense_activation_silu__prompt_kernel
.p2align 8
.type adaLN_cond__sliding_local_dilated__dense_activation_silu__prompt_kernel,@function
adaLN_cond__sliding_local_dilated__dense_activation_silu__prompt_kernel:
    s_cmp_ge_u32 s2, 256
    s_cbranch_scc1 k_end
    s_load_dwordx16 s[4:19], s[0:1], 0
    s_load_dwordx2 s[20:21], s[0:1], 64
    s_load_dwordx2 s[22:23], s[0:1], 80
    v_and_b32 v1, 63, v0
    v_and_b32 v2, 15, v0
    v_bfe_u32 v3, v0, 4, 2
    v_lshrrev_b32 v4, 6, v0
    s_nop 0
    v_readfirstlane_b32 s24, v4
    v_lshlrev_b32 v4, 4, v1
    v_mov_b32 v30, 0
    v_mov_b32 v31, 0
    s_and_b32 s25, s2, 7
    s_lshr_b32 s26, s2, 3
    s_getpc_b64 s[96:97]
pc_ref:
    s_and_b32 s97, s97, 0xffff
    s_mov_b32 s98, k_end - pc_ref
    s_mov_b32 s99, 0x20000
    s_lshl_b32 s33, s26, 2
    s_add_u32 s33, s33, s24
    s_lshl_b32 s33, s33, 9
    v_lshlrev_b32 v5, 3, v1
    buffer_load_dwordx2 a[232:233], v5, s[96:99], s33 offen
    s_lshl_b32 s27, s25, 1
    s_and_b32 s28, s26, 1
    s_add_u32 s27, s27, s28
    s_lshr_b32 s28, s26, 1
    s_mul_i32 s84, s27, 4608
    s_add_u32 s84, s84, 18350080
    s_mul_i32 s3, s27, 37376
    s_add_u32 s3, s3, 18874368
    s_mov_b32 s73, 0
    s_and_b32 s29, s24, 1
    s_lshr_b32 s30, s24, 1
    s_lshl_b32 s31, s27, 7
    s_lshl_b32 s32, s30, 6
    s_add_u32 s31, s31, s32
    s_lshl_b32 s34, s30, 5
    s_lshl_b32 s35, s29, 4
    s_add_u32 s34, s34, s35
    s_lshl_b32 s37, s34, 2
    s_add_u32 s37, s37, 155392
    v_lshrrev_b32 v10, 2, v1
    v_lshlrev_b32 v10, 2, v10
    v_add_u32 v10, s37, v10
    s_mul_i32 s34, s34, 2688
    s_mul_i32 s35, s28, 56
    s_add_u32 s34, s34, s35
    v_lshrrev_b32 v5, 2, v1
    s_movk_i32 s33, 2688
    v_mul_lo_u32 v245, v5, s33
    v_and_b32 v5, 3, v1
    v_lshrrev_b32 v6, 5, v1
    v_lshlrev_b32 v6, 1, v6
    v_xor_b32 v5, v5, v6
    v_lshl_add_u32 v245, v5, 4, v245
    s_mul_i32 s36, s30, 6144
    s_lshl_b32 s38, s29, 10
    s_add_u32 s36, s36, s38
    v_add_u32 v12, s36, v4
    v_add_u32 v13, 130816, v12
    v_lshrrev_b32 v17, 3, v1
    s_movk_i32 s33, 5376
    v_mul_lo_u32 v11, v17, s33
    v_and_b32 v18, 7, v1
    v_lshl_add_u32 v11, v18, 4, v11
    v_lshlrev_b32 v27, 1, v17
    s_sub_u32 s85, s2, 28
    v_lshrrev_b32 v24, 3, v1
    s_movk_i32 s33, 896
    v_mul_lo_u32 v25, v24, s33
    v_lshrrev_b32 v24, 1, v24
    v_and_b32 v26, 7, v1
    v_xor_b32 v24, v24, v26
    v_lshl_add_u32 v24, v24, 4, v25
    s_lshl_b32 s41, s27, 7
    s_sub_u32 s41, s41, 16
    s_mul_i32 s41, s41, 896
    s_sub_u32 s43, s24, 1
    s_mul_i32 s43, s43, 4
    s_add_u32 s43, s43, 4
    s_cmp_eq_u32 s24, 0
    s_cselect_b32 s43, 0, s43
    s_add_u32 s43, s43, s28
    s_add_u32 s43, s43, 2
    s_and_b32 s42, s43, 1
    s_lshl_b32 s42, s42, 6
    v_xor_b32 v24, s42, v24
    v_xor_b32 v25, 64, v24
    s_mov_b32 s50, 0x1c0000
    s_mov_b32 s51, 0x20000
    s_mov_b32 s54, 0x10000000
    s_mov_b32 s55, 0x20000
    s_mov_b32 s66, 0x380
    s_mov_b32 s67, 0x20000
    s_mov_b32 s94, 0x24c000
    s_mov_b32 s95, 0x20000
    v_mov_b32 v15, 0
    s_mov_b32 s40, 32768
    s_and_b32 s45, s2, 1
    s_lshl_b32 s45, s45, 2
    s_add_u32 s45, s45, s24
    s_mul_i32 s45, s45, 56
    s_lshr_b32 s47, s2, 1
    s_mul_i32 s46, s45, 5376
    s_lshl_b32 s45, s45, 1
    s_lshl_b32 s39, s47, 7
    s_add_u32 s46, s46, s39
    s_waitcnt lgkmcnt(0)
    s_mov_b32 s52, s22
    s_and_b32 s53, s23, 0xffff
    buffer_load_dword v16, v15, s[52:55], s40 offen sc1
    s_mov_b32 s64, s16
    s_and_b32 s65, s17, 0xffff
    s_mov_b32 s92, s18
    s_and_b32 s93, s19, 0xffff
    s_mov_b32 s48, s4
    s_and_b32 s49, s5, 0xffff
    s_cmp_ge_u32 s2, 28
    s_cbranch_scc1 nomod0
    buffer_load_ushort v32, v27, s[64:67], s45 offen offset:0
    buffer_load_ushort v33, v27, s[64:67], s45 offen offset:16
    buffer_load_ushort v34, v27, s[64:67], s45 offen offset:32
    buffer_load_ushort v35, v27, s[64:67], s45 offen offset:48
    buffer_load_ushort v36, v27, s[64:67], s45 offen offset:64
    buffer_load_ushort v37, v27, s[64:67], s45 offen offset:80
    buffer_load_ushort v38, v27, s[64:67], s45 offen offset:96
    s_add_u32 s39, s46, 0
    buffer_load_dwordx4 v[48:51], v11, s[92:95], s39 offen nt
    s_add_u32 s39, s46, 43008
    buffer_load_dwordx4 v[52:55], v11, s[92:95], s39 offen nt
    s_add_u32 s39, s46, 86016
    buffer_load_dwordx4 v[56:59], v11, s[92:95], s39 offen nt
    s_add_u32 s39, s46, 129024
    buffer_load_dwordx4 v[60:63], v11, s[92:95], s39 offen nt
    s_add_u32 s39, s46, 172032
    buffer_load_dwordx4 v[64:67], v11, s[92:95], s39 offen nt
    s_add_u32 s39, s46, 215040
    buffer_load_dwordx4 v[68:71], v11, s[92:95], s39 offen nt
    s_add_u32 s39, s46, 258048
    buffer_load_dwordx4 v[72:75], v11, s[92:95], s39 offen nt
nomod0:
    s_cmp_ge_u32 s2, 28
    s_cbranch_scc1 nomod
    v_lshrrev_b32 v19, 4, v0
    v_lshlrev_b32 v19, 8, v19
    v_lshl_add_u32 v19, v18, 5, v19
    v_add_u32 v19, 157184, v19
    v_lshlrev_b32 v30, 2, v1
    v_add_u32 v20, 157184, v30
    v_lshlrev_b32 v30, 3, v1
    s_lshl_b32 s38, s2, 9
    s_lshl_b32 s39, s24, 16
    s_add_u32 s38, s38, s39
    s_add_u32 s38, s38, 262144
    s_waitcnt vmcnt(7)
    v_readfirstlane_b32 s72, v16
    s_nop 0
    s_add_u32 s72, s72, 16
    s_waitcnt vmcnt(7)
    s_mov_b32 s46, 0x3fb8aa3b
    v_lshlrev_b32 v32, 16, v32
    v_mul_f32 v76, s46, v32
    v_lshlrev_b32 v33, 16, v33
    v_mul_f32 v77, s46, v33
    v_lshlrev_b32 v34, 16, v34
    v_mul_f32 v78, s46, v34
    v_lshlrev_b32 v35, 16, v35
    v_mul_f32 v79, s46, v35
    v_lshlrev_b32 v36, 16, v36
    v_mul_f32 v80, s46, v36
    v_lshlrev_b32 v37, 16, v37
    v_mul_f32 v81, s46, v37
    v_lshlrev_b32 v38, 16, v38
    v_mul_f32 v82, s46, v38
    v_exp_f32 v76, -v76
    v_exp_f32 v77, -v77
    v_exp_f32 v78, -v78
    v_exp_f32 v79, -v79
    v_exp_f32 v80, -v80
    v_exp_f32 v81, -v81
    v_exp_f32 v82, -v82
    v_add_f32 v76, 1.0, v76
    v_add_f32 v77, 1.0, v77
    v_add_f32 v78, 1.0, v78
    v_add_f32 v79, 1.0, v79
    v_add_f32 v80, 1.0, v80
    v_add_f32 v81, 1.0, v81
    v_add_f32 v82, 1.0, v82
    v_rcp_f32 v76, v76
    v_rcp_f32 v77, v77
    v_rcp_f32 v78, v78
    v_rcp_f32 v79, v79
    v_rcp_f32 v80, v80
    v_rcp_f32 v81, v81
    v_rcp_f32 v82, v82
    v_mul_f32 v76, v76, v32
    v_mul_f32 v77, v77, v33
    v_mul_f32 v78, v78, v34
    v_mul_f32 v79, v79, v35
    v_mul_f32 v80, v80, v36
    v_mul_f32 v81, v81, v37
    v_mul_f32 v82, v82, v38
    v_cvt_pk_bf16_f32 v76, v76, v76
    v_cvt_pk_bf16_f32 v77, v77, v77
    v_cvt_pk_bf16_f32 v78, v78, v78
    v_cvt_pk_bf16_f32 v79, v79, v79
    v_cvt_pk_bf16_f32 v80, v80, v80
    v_cvt_pk_bf16_f32 v81, v81, v81
    v_cvt_pk_bf16_f32 v82, v82, v82
    v_and_b32 v32, 0xffff, v76
    v_and_b32 v76, 0xffff0000, v76
    v_and_b32 v33, 0xffff, v77
    v_and_b32 v77, 0xffff0000, v77
    v_and_b32 v34, 0xffff, v78
    v_and_b32 v78, 0xffff0000, v78
    v_and_b32 v35, 0xffff, v79
    v_and_b32 v79, 0xffff0000, v79
    v_and_b32 v36, 0xffff, v80
    v_and_b32 v80, 0xffff0000, v80
    v_and_b32 v37, 0xffff, v81
    v_and_b32 v81, 0xffff0000, v81
    v_and_b32 v38, 0xffff, v82
    v_and_b32 v82, 0xffff0000, v82
    s_waitcnt vmcnt(6)
    v_dot2_f32_bf16 v84, v48, v32, 0
    v_dot2_f32_bf16 v85, v48, v76, 0
    v_dot2_f32_bf16 v86, v49, v32, 0
    v_dot2_f32_bf16 v87, v49, v76, 0
    v_dot2_f32_bf16 v88, v50, v32, 0
    v_dot2_f32_bf16 v89, v50, v76, 0
    v_dot2_f32_bf16 v90, v51, v32, 0
    v_dot2_f32_bf16 v91, v51, v76, 0
    s_waitcnt vmcnt(5)
    v_dot2_f32_bf16 v84, v52, v33, v84
    v_dot2_f32_bf16 v85, v52, v77, v85
    v_dot2_f32_bf16 v86, v53, v33, v86
    v_dot2_f32_bf16 v87, v53, v77, v87
    v_dot2_f32_bf16 v88, v54, v33, v88
    v_dot2_f32_bf16 v89, v54, v77, v89
    v_dot2_f32_bf16 v90, v55, v33, v90
    v_dot2_f32_bf16 v91, v55, v77, v91
    s_waitcnt vmcnt(4)
    v_dot2_f32_bf16 v84, v56, v34, v84
    v_dot2_f32_bf16 v85, v56, v78, v85
    v_dot2_f32_bf16 v86, v57, v34, v86
    v_dot2_f32_bf16 v87, v57, v78, v87
    v_dot2_f32_bf16 v88, v58, v34, v88
    v_dot2_f32_bf16 v89, v58, v78, v89
    v_dot2_f32_bf16 v90, v59, v34, v90
    v_dot2_f32_bf16 v91, v59, v78, v91
    s_waitcnt vmcnt(3)
    v_dot2_f32_bf16 v84, v60, v35, v84
    v_dot2_f32_bf16 v85, v60, v79, v85
    v_dot2_f32_bf16 v86, v61, v35, v86
    v_dot2_f32_bf16 v87, v61, v79, v87
    v_dot2_f32_bf16 v88, v62, v35, v88
    v_dot2_f32_bf16 v89, v62, v79, v89
    v_dot2_f32_bf16 v90, v63, v35, v90
    v_dot2_f32_bf16 v91, v63, v79, v91
    s_waitcnt vmcnt(2)
    v_dot2_f32_bf16 v84, v64, v36, v84
    v_dot2_f32_bf16 v85, v64, v80, v85
    v_dot2_f32_bf16 v86, v65, v36, v86
    v_dot2_f32_bf16 v87, v65, v80, v87
    v_dot2_f32_bf16 v88, v66, v36, v88
    v_dot2_f32_bf16 v89, v66, v80, v89
    v_dot2_f32_bf16 v90, v67, v36, v90
    v_dot2_f32_bf16 v91, v67, v80, v91
    s_waitcnt vmcnt(1)
    v_dot2_f32_bf16 v84, v68, v37, v84
    v_dot2_f32_bf16 v85, v68, v81, v85
    v_dot2_f32_bf16 v86, v69, v37, v86
    v_dot2_f32_bf16 v87, v69, v81, v87
    v_dot2_f32_bf16 v88, v70, v37, v88
    v_dot2_f32_bf16 v89, v70, v81, v89
    v_dot2_f32_bf16 v90, v71, v37, v90
    v_dot2_f32_bf16 v91, v71, v81, v91
    s_waitcnt vmcnt(0)
    v_dot2_f32_bf16 v84, v72, v38, v84
    v_dot2_f32_bf16 v85, v72, v82, v85
    v_dot2_f32_bf16 v86, v73, v38, v86
    v_dot2_f32_bf16 v87, v73, v82, v87
    v_dot2_f32_bf16 v88, v74, v38, v88
    v_dot2_f32_bf16 v89, v74, v82, v89
    v_dot2_f32_bf16 v90, v75, v38, v90
    v_dot2_f32_bf16 v91, v75, v82, v91
    s_nop 2
    v_add_f32_dpp v84, v84, v84 row_ror:8 row_mask:0xf bank_mask:0xf
    v_add_f32_dpp v85, v85, v85 row_ror:8 row_mask:0xf bank_mask:0xf
    v_add_f32_dpp v86, v86, v86 row_ror:8 row_mask:0xf bank_mask:0xf
    v_add_f32_dpp v87, v87, v87 row_ror:8 row_mask:0xf bank_mask:0xf
    v_add_f32_dpp v88, v88, v88 row_ror:8 row_mask:0xf bank_mask:0xf
    v_add_f32_dpp v89, v89, v89 row_ror:8 row_mask:0xf bank_mask:0xf
    v_add_f32_dpp v90, v90, v90 row_ror:8 row_mask:0xf bank_mask:0xf
    v_add_f32_dpp v91, v91, v91 row_ror:8 row_mask:0xf bank_mask:0xf
    s_mov_b32 s44, 0x00ff00ff
    s_mov_b32 s45, 0x00ff00ff
    s_mov_b64 exec, s[44:45]
    ds_write_b128 v19, v[84:87]
    ds_write_b128 v19, v[88:91] offset:16
    s_mov_b64 exec, -1
    s_waitcnt lgkmcnt(0)
    s_barrier
    ds_read_b32 v32, v20 offset:0
    ds_read_b32 v33, v20 offset:256
    ds_read_b32 v34, v20 offset:512
    ds_read_b32 v35, v20 offset:768
    ds_read_b32 v36, v20 offset:1024
    ds_read_b32 v37, v20 offset:1280
    ds_read_b32 v38, v20 offset:1536
    ds_read_b32 v39, v20 offset:1792
    ds_read_b32 v40, v20 offset:2048
    ds_read_b32 v41, v20 offset:2304
    ds_read_b32 v42, v20 offset:2560
    ds_read_b32 v43, v20 offset:2816
    s_waitcnt lgkmcnt(4)
    ds_read_b32 v44, v20 offset:3072
    ds_read_b32 v45, v20 offset:3328
    ds_read_b32 v46, v20 offset:3584
    ds_read_b32 v47, v20 offset:3840
    v_add_f32 v32, v32, v36
    v_add_f32 v33, v33, v37
    v_add_f32 v34, v34, v38
    v_add_f32 v35, v35, v39
    s_waitcnt lgkmcnt(0)
    v_add_f32 v40, v40, v44
    v_add_f32 v41, v41, v45
    v_add_f32 v42, v42, v46
    v_add_f32 v43, v43, v47
    v_add_f32 v32, v32, v40
    v_add_f32 v33, v33, v41
    v_add_f32 v34, v34, v42
    v_add_f32 v35, v35, v43
    v_add_f32 v32, v32, v33
    v_add_f32 v34, v34, v35
    v_add_f32 v32, v32, v34
    v_mov_b32 v33, s72
    buffer_store_dwordx2 v[32:33], v30, s[52:55], s38 offen sc1
    s_add_u32 s38, s38, 16384
    buffer_store_dwordx2 v[32:33], v30, s[52:55], s38 offen sc1
    s_add_u32 s38, s38, 16384
    buffer_store_dwordx2 v[32:33], v30, s[52:55], s38 offen sc1
    s_add_u32 s38, s38, 16384
    buffer_store_dwordx2 v[32:33], v30, s[52:55], s38 offen sc1
nomod:
    s_mov_b32 s56, s6
    s_and_b32 s57, s7, 0xffff
    s_mov_b32 s58, 0x126000
    s_mov_b32 s59, 0x20000
    s_mov_b32 s68, s20
    s_and_b32 s69, s21, 0xffff
    s_mov_b32 s70, 0x1c0000
    s_mov_b32 s71, 0x20000
    s_cmp_lg_u32 s24, 0
    s_cbranch_scc1 nw0_1
    s_cmp_ge_u32 s43, 18
    s_cselect_b32 s42, 18, 0
    s_sub_u32 s43, s43, s42
    s_lshl_b32 s88, s43, 10
    s_mul_i32 s89, s43, 7168
    s_add_u32 s89, s89, s41
    s_add_u32 s43, s43, 1
    s_add_u32 m0, s88, 0
    s_add_u32 s39, s89, 0
    buffer_load_dwordx4 v24, s[48:51], s39 offen nt lds
    s_add_u32 m0, s88, 18688
    s_add_u32 s39, s89, 128
    buffer_load_dwordx4 v24, s[48:51], s39 offen nt lds
    s_add_u32 m0, s88, 37376
    s_add_u32 s39, s89, 256
    buffer_load_dwordx4 v24, s[48:51], s39 offen nt lds
    s_add_u32 m0, s88, 56064
    s_add_u32 s39, s89, 384
    buffer_load_dwordx4 v24, s[48:51], s39 offen nt lds
    s_add_u32 m0, s88, 74752
    s_add_u32 s39, s89, 512
    buffer_load_dwordx4 v24, s[48:51], s39 offen nt lds
    s_add_u32 m0, s88, 93440
    s_add_u32 s39, s89, 640
    buffer_load_dwordx4 v24, s[48:51], s39 offen nt lds
    s_add_u32 m0, s88, 112128
    s_add_u32 s39, s89, 768
    buffer_load_dwordx4 v24, s[48:51], s39 offen nt lds
    s_cmp_ge_u32 s85, 224
    s_cbranch_scc1 no_lp0
    s_and_b32 s45, s85, 7
    s_mul_i32 s45, s45, 56
    s_lshr_b32 s47, s85, 3
    s_add_u32 s47, s47, 14
    s_mul_i32 s46, s45, 5376
    s_lshl_b32 s45, s45, 1
    s_lshl_b32 s39, s47, 7
    s_add_u32 s46, s46, s39
    buffer_load_ushort v32, v27, s[64:67], s45 offen offset:0
    buffer_load_ushort v33, v27, s[64:67], s45 offen offset:16
    buffer_load_ushort v34, v27, s[64:67], s45 offen offset:32
    buffer_load_ushort v35, v27, s[64:67], s45 offen offset:48
    buffer_load_ushort v36, v27, s[64:67], s45 offen offset:64
    buffer_load_ushort v37, v27, s[64:67], s45 offen offset:80
    buffer_load_ushort v38, v27, s[64:67], s45 offen offset:96
    s_add_u32 s39, s46, 0
    buffer_load_dwordx4 v[48:51], v11, s[92:95], s39 offen nt
    s_add_u32 s39, s46, 43008
    buffer_load_dwordx4 v[52:55], v11, s[92:95], s39 offen nt
    s_add_u32 s39, s46, 86016
    buffer_load_dwordx4 v[56:59], v11, s[92:95], s39 offen nt
    s_add_u32 s39, s46, 129024
    buffer_load_dwordx4 v[60:63], v11, s[92:95], s39 offen nt
    s_add_u32 s39, s46, 172032
    buffer_load_dwordx4 v[64:67], v11, s[92:95], s39 offen nt
    s_add_u32 s39, s46, 215040
    buffer_load_dwordx4 v[68:71], v11, s[92:95], s39 offen nt
    s_add_u32 s39, s46, 258048
    buffer_load_dwordx4 v[72:75], v11, s[92:95], s39 offen nt
no_lp0:
    s_cmp_ge_u32 s43, 18
    s_cselect_b32 s42, 18, 0
    s_sub_u32 s43, s43, s42
    s_lshl_b32 s88, s43, 10
    s_mul_i32 s89, s43, 7168
    s_add_u32 s89, s89, s41
    s_add_u32 s43, s43, 1
    s_add_u32 m0, s88, 0
    s_add_u32 s39, s89, 0
    buffer_load_dwordx4 v25, s[48:51], s39 offen nt lds
    s_add_u32 m0, s88, 18688
    s_add_u32 s39, s89, 128
    buffer_load_dwordx4 v25, s[48:51], s39 offen nt lds
    s_add_u32 m0, s88, 37376
    s_add_u32 s39, s89, 256
    buffer_load_dwordx4 v25, s[48:51], s39 offen nt lds
    s_add_u32 m0, s88, 56064
    s_add_u32 s39, s89, 384
    buffer_load_dwordx4 v25, s[48:51], s39 offen nt lds
    s_add_u32 m0, s88, 74752
    s_add_u32 s39, s89, 512
    buffer_load_dwordx4 v25, s[48:51], s39 offen nt lds
    s_add_u32 m0, s88, 93440
    s_add_u32 s39, s89, 640
    buffer_load_dwordx4 v25, s[48:51], s39 offen nt lds
    s_add_u32 m0, s88, 112128
    s_add_u32 s39, s89, 768
    buffer_load_dwordx4 v25, s[48:51], s39 offen nt lds
    s_cmp_ge_u32 s43, 18
    s_cselect_b32 s42, 18, 0
    s_sub_u32 s43, s43, s42
    s_lshl_b32 s88, s43, 10
    s_mul_i32 s89, s43, 7168
    s_add_u32 s89, s89, s41
    s_add_u32 s43, s43, 1
    s_add_u32 m0, s88, 0
    s_add_u32 s39, s89, 0
    buffer_load_dwordx4 v24, s[48:51], s39 offen nt lds
    s_add_u32 m0, s88, 18688
    s_add_u32 s39, s89, 128
    buffer_load_dwordx4 v24, s[48:51], s39 offen nt lds
    s_add_u32 m0, s88, 37376
    s_add_u32 s39, s89, 256
    buffer_load_dwordx4 v24, s[48:51], s39 offen nt lds
    s_add_u32 m0, s88, 56064
    s_add_u32 s39, s89, 384
    buffer_load_dwordx4 v24, s[48:51], s39 offen nt lds
    s_add_u32 m0, s88, 74752
    s_add_u32 s39, s89, 512
    buffer_load_dwordx4 v24, s[48:51], s39 offen nt lds
    s_add_u32 m0, s88, 93440
    s_add_u32 s39, s89, 640
    buffer_load_dwordx4 v24, s[48:51], s39 offen nt lds
    s_add_u32 m0, s88, 112128
    s_add_u32 s39, s89, 768
    buffer_load_dwordx4 v24, s[48:51], s39 offen nt lds
    s_cmp_ge_u32 s43, 18
    s_cselect_b32 s42, 18, 0
    s_sub_u32 s43, s43, s42
    s_lshl_b32 s88, s43, 10
    s_mul_i32 s89, s43, 7168
    s_add_u32 s89, s89, s41
    s_add_u32 s43, s43, 1
    s_add_u32 m0, s88, 0
    s_add_u32 s39, s89, 0
    buffer_load_dwordx4 v25, s[48:51], s39 offen nt lds
    s_add_u32 m0, s88, 18688
    s_add_u32 s39, s89, 128
    buffer_load_dwordx4 v25, s[48:51], s39 offen nt lds
    s_add_u32 m0, s88, 37376
    s_add_u32 s39, s89, 256
    buffer_load_dwordx4 v25, s[48:51], s39 offen nt lds
    s_add_u32 m0, s88, 56064
    s_add_u32 s39, s89, 384
    buffer_load_dwordx4 v25, s[48:51], s39 offen nt lds
    s_add_u32 m0, s88, 74752
    s_add_u32 s39, s89, 512
    buffer_load_dwordx4 v25, s[48:51], s39 offen nt lds
    s_add_u32 m0, s88, 93440
    s_add_u32 s39, s89, 640
    buffer_load_dwordx4 v25, s[48:51], s39 offen nt lds
    s_add_u32 m0, s88, 112128
    s_add_u32 s39, s89, 768
    buffer_load_dwordx4 v25, s[48:51], s39 offen nt lds
    v_mul_u32_u24 v19, 18688, v17
    v_lshl_add_u32 v19, v18, 4, v19
    v_mov_b32 v196, 0x3f803f80
    v_mov_b32 v197, 0x3f803f80
    v_mov_b32 v198, 0x3f803f80
    v_mov_b32 v199, 0x3f803f80
    s_mov_b32 s46, -1
    s_mov_b32 s47, 0x00ffffff
    s_mov_b64 exec, s[46:47]
    ds_write_b128 v19, v[196:199] offset:18432
    s_mov_b64 exec, -1
    v_lshrrev_b32 v19, 2, v2
    v_and_b32 v20, 1, v2
    v_lshl_add_u32 v20, v19, 1, v20
    s_lshl_b32 s46, s28, 3
    s_add_u32 s46, s46, 16
    v_add_u32 v20, s46, v20
    v_bfe_u32 v21, v20, 1, 3
    v_xor_b32 v21, v21, v3
    v_lshlrev_b32 v20, 7, v20
    v_lshl_add_u32 v20, v21, 4, v20
    v_lshlrev_b32 v21, 4, v3
    v_add_u32 v21, 18432, v21
    v_and_b32 v19, 2, v2
    v_cmp_eq_u32 vcc, 0, v19
    s_nop 1
    v_cndmask_b32 v20, v21, v20, vcc
    v_xor_b32 v21, 64, v20
    v_add_u32 v22, 74752, v20
    v_add_u32 v23, 74752, v21
    v_and_b32 v19, 1, v2
    v_cmp_eq_u32 s[88:89], 1, v19
    v_lshlrev_b32 v19, 14, v19
    v_lshl_add_u32 v19, v3, 4, v19
    s_lshl_b32 s44, s27, 4
    s_add_u32 s44, s44, s28
    s_lshl_b32 s86, s44, 2
    s_add_u32 s86, s86, 34816
    s_lshl_b32 s44, s44, 6
    s_add_u32 s44, s44, 65536
    s_mov_b32 s46, 0x3b124925
    s_mov_b32 s47, 0x3727c5ac
    s_waitcnt vmcnt(21) lgkmcnt(0)
    ds_read_b128 a[0:3], v20 offset:0
    ds_read_b128 a[4:7], v21 offset:0
    ds_read_b128 a[8:11], v20 offset:18688
    ds_read_b128 a[12:15], v21 offset:18688
    ds_read_b128 a[16:19], v20 offset:37376
    ds_read_b128 a[20:23], v21 offset:37376
    ds_read_b128 a[24:27], v20 offset:56064
    ds_read_b128 a[28:31], v21 offset:56064
    ds_read_b128 a[32:35], v22 offset:0
    ds_read_b128 a[36:39], v23 offset:0
    ds_read_b128 a[40:43], v22 offset:18688
    ds_read_b128 a[44:47], v23 offset:18688
    ds_read_b128 a[48:51], v22 offset:37376
    ds_read_b128 a[52:55], v23 offset:37376
    v_readfirstlane_b32 s72, v16
    s_nop 0
    s_add_u32 s72, s72, 16
    s_waitcnt lgkmcnt(13)
    v_mfma_f32_16x16x32_bf16 v[196:199], a[0:3], a[0:3], 0
    s_waitcnt lgkmcnt(12)
    v_mfma_f32_16x16x32_bf16 v[196:199], a[4:7], a[4:7], v[196:199]
    s_waitcnt lgkmcnt(11)
    v_mfma_f32_16x16x32_bf16 v[196:199], a[8:11], a[8:11], v[196:199]
    s_waitcnt lgkmcnt(10)
    v_mfma_f32_16x16x32_bf16 v[196:199], a[12:15], a[12:15], v[196:199]
    s_waitcnt lgkmcnt(9)
    v_mfma_f32_16x16x32_bf16 v[196:199], a[16:19], a[16:19], v[196:199]
    s_waitcnt lgkmcnt(8)
    v_mfma_f32_16x16x32_bf16 v[196:199], a[20:23], a[20:23], v[196:199]
    s_waitcnt lgkmcnt(7)
    v_mfma_f32_16x16x32_bf16 v[196:199], a[24:27], a[24:27], v[196:199]
    s_waitcnt lgkmcnt(6)
    v_mfma_f32_16x16x32_bf16 v[196:199], a[28:31], a[28:31], v[196:199]
    s_waitcnt lgkmcnt(5)
    v_mfma_f32_16x16x32_bf16 v[196:199], a[32:35], a[32:35], v[196:199]
    s_waitcnt lgkmcnt(4)
    v_mfma_f32_16x16x32_bf16 v[196:199], a[36:39], a[36:39], v[196:199]
    s_waitcnt lgkmcnt(3)
    v_mfma_f32_16x16x32_bf16 v[196:199], a[40:43], a[40:43], v[196:199]
    s_waitcnt lgkmcnt(2)
    v_mfma_f32_16x16x32_bf16 v[196:199], a[44:47], a[44:47], v[196:199]
    s_waitcnt lgkmcnt(1)
    v_mfma_f32_16x16x32_bf16 v[196:199], a[48:51], a[48:51], v[196:199]
    s_waitcnt lgkmcnt(0)
    v_mfma_f32_16x16x32_bf16 v[196:199], a[52:55], a[52:55], v[196:199]
    s_nop 7
    v_cndmask_b32 v197, v196, v197, s[88:89]
    v_mov_b32 v196, v198
    v_mul_f32 v196, s46, v196
    v_mul_f32 v197, s46, v197
    v_fma_f32 v197, -v196, v196, v197
    v_max_f32 v197, 0, v197
    v_cvt_pk_bf16_f32 v196, v196, v196
    v_lshlrev_b32 v196, 16, v196
    v_cvt_pk_bf16_f32 v197, v197, v197
    v_lshlrev_b32 v197, 16, v197
    v_add_f32 v197, s47, v197
    v_cvt_pk_bf16_f32 v197, v197, v197
    v_lshlrev_b32 v197, 16, v197
    v_sqrt_f32 v197, v197
    s_nop 0
    v_cvt_pk_bf16_f32 v197, v197, v197
    v_lshlrev_b32 v197, 16, v197
    v_rcp_f32 v197, v197
    v_mov_b32 v198, s72
    v_mov_b32 v199, s72
    s_mov_b32 s46, 0x00300003
    s_mov_b32 s47, 0x30000300
    s_mov_b64 exec, s[46:47]
    buffer_store_dwordx4 v[196:199], v19, s[52:55], s44 offen sc1
    s_mov_b64 exec, -1
    s_add_u32 s39, s34, 0
    buffer_load_dwordx4 v[104:107], v245, s[56:59], s39 offen
    s_add_u32 s39, s34, 896
    buffer_load_dwordx4 v[108:111], v245, s[56:59], s39 offen
    s_add_u32 s39, s34, 1792
    buffer_load_dwordx4 v[112:115], v245, s[56:59], s39 offen
    s_cmp_ge_u32 s85, 224
    s_cbranch_scc1 no_lp
    v_and_b32 v20, 1, v17
    v_cmp_eq_u32 s[88:89], 1, v20
    v_and_b32 v20, 2, v17
    v_cmp_eq_u32 s[90:91], 2, v20
    v_and_b32 v20, 4, v17
    v_cmp_eq_u32 s[96:97], 4, v20
    s_mov_b32 s46, 0x3fb8aa3b
    v_lshlrev_b32 v32, 16, v32
    v_mul_f32 v76, s46, v32
    v_lshlrev_b32 v33, 16, v33
    v_mul_f32 v77, s46, v33
    v_lshlrev_b32 v34, 16, v34
    v_mul_f32 v78, s46, v34
    v_lshlrev_b32 v35, 16, v35
    v_mul_f32 v79, s46, v35
    v_lshlrev_b32 v36, 16, v36
    v_mul_f32 v80, s46, v36
    v_lshlrev_b32 v37, 16, v37
    v_mul_f32 v81, s46, v37
    v_lshlrev_b32 v38, 16, v38
    v_mul_f32 v82, s46, v38
    v_exp_f32 v76, -v76
    v_exp_f32 v77, -v77
    v_exp_f32 v78, -v78
    v_exp_f32 v79, -v79
    v_exp_f32 v80, -v80
    v_exp_f32 v81, -v81
    v_exp_f32 v82, -v82
    v_add_f32 v76, 1.0, v76
    v_add_f32 v77, 1.0, v77
    v_add_f32 v78, 1.0, v78
    v_add_f32 v79, 1.0, v79
    v_add_f32 v80, 1.0, v80
    v_add_f32 v81, 1.0, v81
    v_add_f32 v82, 1.0, v82
    v_rcp_f32 v76, v76
    v_rcp_f32 v77, v77
    v_rcp_f32 v78, v78
    v_rcp_f32 v79, v79
    v_rcp_f32 v80, v80
    v_rcp_f32 v81, v81
    v_rcp_f32 v82, v82
    v_mul_f32 v76, v76, v32
    v_mul_f32 v77, v77, v33
    v_mul_f32 v78, v78, v34
    v_mul_f32 v79, v79, v35
    v_mul_f32 v80, v80, v36
    v_mul_f32 v81, v81, v37
    v_mul_f32 v82, v82, v38
    v_cvt_pk_bf16_f32 v76, v76, v76
    v_cvt_pk_bf16_f32 v77, v77, v77
    v_cvt_pk_bf16_f32 v78, v78, v78
    v_cvt_pk_bf16_f32 v79, v79, v79
    v_cvt_pk_bf16_f32 v80, v80, v80
    v_cvt_pk_bf16_f32 v81, v81, v81
    v_cvt_pk_bf16_f32 v82, v82, v82
    v_and_b32 v32, 0xffff, v76
    v_and_b32 v76, 0xffff0000, v76
    v_and_b32 v33, 0xffff, v77
    v_and_b32 v77, 0xffff0000, v77
    v_and_b32 v34, 0xffff, v78
    v_and_b32 v78, 0xffff0000, v78
    v_and_b32 v35, 0xffff, v79
    v_and_b32 v79, 0xffff0000, v79
    v_and_b32 v36, 0xffff, v80
    v_and_b32 v80, 0xffff0000, v80
    v_and_b32 v37, 0xffff, v81
    v_and_b32 v81, 0xffff0000, v81
    v_and_b32 v38, 0xffff, v82
    v_and_b32 v82, 0xffff0000, v82
    v_dot2_f32_bf16 v84, v48, v32, 0
    v_dot2_f32_bf16 v85, v48, v76, 0
    v_dot2_f32_bf16 v86, v49, v32, 0
    v_dot2_f32_bf16 v87, v49, v76, 0
    v_dot2_f32_bf16 v88, v50, v32, 0
    v_dot2_f32_bf16 v89, v50, v76, 0
    v_dot2_f32_bf16 v90, v51, v32, 0
    v_dot2_f32_bf16 v91, v51, v76, 0
    v_dot2_f32_bf16 v84, v52, v33, v84
    v_dot2_f32_bf16 v85, v52, v77, v85
    v_dot2_f32_bf16 v86, v53, v33, v86
    v_dot2_f32_bf16 v87, v53, v77, v87
    v_dot2_f32_bf16 v88, v54, v33, v88
    v_dot2_f32_bf16 v89, v54, v77, v89
    v_dot2_f32_bf16 v90, v55, v33, v90
    v_dot2_f32_bf16 v91, v55, v77, v91
    v_dot2_f32_bf16 v84, v56, v34, v84
    v_dot2_f32_bf16 v85, v56, v78, v85
    v_dot2_f32_bf16 v86, v57, v34, v86
    v_dot2_f32_bf16 v87, v57, v78, v87
    v_dot2_f32_bf16 v88, v58, v34, v88
    v_dot2_f32_bf16 v89, v58, v78, v89
    v_dot2_f32_bf16 v90, v59, v34, v90
    v_dot2_f32_bf16 v91, v59, v78, v91
    v_dot2_f32_bf16 v84, v60, v35, v84
    v_dot2_f32_bf16 v85, v60, v79, v85
    v_dot2_f32_bf16 v86, v61, v35, v86
    v_dot2_f32_bf16 v87, v61, v79, v87
    v_dot2_f32_bf16 v88, v62, v35, v88
    v_dot2_f32_bf16 v89, v62, v79, v89
    v_dot2_f32_bf16 v90, v63, v35, v90
    v_dot2_f32_bf16 v91, v63, v79, v91
    v_dot2_f32_bf16 v84, v64, v36, v84
    v_dot2_f32_bf16 v85, v64, v80, v85
    v_dot2_f32_bf16 v86, v65, v36, v86
    v_dot2_f32_bf16 v87, v65, v80, v87
    v_dot2_f32_bf16 v88, v66, v36, v88
    v_dot2_f32_bf16 v89, v66, v80, v89
    v_dot2_f32_bf16 v90, v67, v36, v90
    v_dot2_f32_bf16 v91, v67, v80, v91
    v_dot2_f32_bf16 v84, v68, v37, v84
    v_dot2_f32_bf16 v85, v68, v81, v85
    v_dot2_f32_bf16 v86, v69, v37, v86
    v_dot2_f32_bf16 v87, v69, v81, v87
    v_dot2_f32_bf16 v88, v70, v37, v88
    v_dot2_f32_bf16 v89, v70, v81, v89
    v_dot2_f32_bf16 v90, v71, v37, v90
    v_dot2_f32_bf16 v91, v71, v81, v91
    v_dot2_f32_bf16 v84, v72, v38, v84
    v_dot2_f32_bf16 v85, v72, v82, v85
    v_dot2_f32_bf16 v86, v73, v38, v86
    v_dot2_f32_bf16 v87, v73, v82, v87
    v_dot2_f32_bf16 v88, v74, v38, v88
    v_dot2_f32_bf16 v89, v74, v82, v89
    v_dot2_f32_bf16 v90, v75, v38, v90
    v_dot2_f32_bf16 v91, v75, v82, v91
    v_add_f32_dpp v84, v84, v84 row_ror:8 row_mask:0xf bank_mask:0xf
    v_add_f32_dpp v85, v85, v85 row_ror:8 row_mask:0xf bank_mask:0xf
    v_add_f32_dpp v86, v86, v86 row_ror:8 row_mask:0xf bank_mask:0xf
    v_add_f32_dpp v87, v87, v87 row_ror:8 row_mask:0xf bank_mask:0xf
    v_add_f32_dpp v88, v88, v88 row_ror:8 row_mask:0xf bank_mask:0xf
    v_add_f32_dpp v89, v89, v89 row_ror:8 row_mask:0xf bank_mask:0xf
    v_add_f32_dpp v90, v90, v90 row_ror:8 row_mask:0xf bank_mask:0xf
    v_add_f32_dpp v91, v91, v91 row_ror:8 row_mask:0xf bank_mask:0xf
    v_mov_b32 v32, v84
    v_mov_b32 v33, v85
    v_mov_b32 v34, v86
    v_mov_b32 v35, v87
    v_mov_b32 v36, v88
    v_mov_b32 v37, v89
    v_mov_b32 v38, v90
    v_mov_b32 v39, v91
    v_permlane16_swap_b32 v84, v32
    v_permlane16_swap_b32 v85, v33
    v_permlane16_swap_b32 v86, v34
    v_permlane16_swap_b32 v87, v35
    v_permlane16_swap_b32 v88, v36
    v_permlane16_swap_b32 v89, v37
    v_permlane16_swap_b32 v90, v38
    v_permlane16_swap_b32 v91, v39
    v_add_f32 v84, v84, v32
    v_add_f32 v85, v85, v33
    v_add_f32 v86, v86, v34
    v_add_f32 v87, v87, v35
    v_add_f32 v88, v88, v36
    v_add_f32 v89, v89, v37
    v_add_f32 v90, v90, v38
    v_add_f32 v91, v91, v39
    v_mov_b32 v32, v84
    v_mov_b32 v33, v85
    v_mov_b32 v34, v86
    v_mov_b32 v35, v87
    v_mov_b32 v36, v88
    v_mov_b32 v37, v89
    v_mov_b32 v38, v90
    v_mov_b32 v39, v91
    v_permlane32_swap_b32 v84, v32
    v_permlane32_swap_b32 v85, v33
    v_permlane32_swap_b32 v86, v34
    v_permlane32_swap_b32 v87, v35
    v_permlane32_swap_b32 v88, v36
    v_permlane32_swap_b32 v89, v37
    v_permlane32_swap_b32 v90, v38
    v_permlane32_swap_b32 v91, v39
    v_add_f32 v84, v84, v32
    v_add_f32 v85, v85, v33
    v_add_f32 v86, v86, v34
    v_add_f32 v87, v87, v35
    v_add_f32 v88, v88, v36
    v_add_f32 v89, v89, v37
    v_add_f32 v90, v90, v38
    v_add_f32 v91, v91, v39
    v_cndmask_b32 v84, v84, v85, s[88:89]
    v_cndmask_b32 v86, v86, v87, s[88:89]
    v_cndmask_b32 v88, v88, v89, s[88:89]
    v_cndmask_b32 v90, v90, v91, s[88:89]
    v_cndmask_b32 v84, v84, v86, s[90:91]
    v_cndmask_b32 v88, v88, v90, s[90:91]
    v_cndmask_b32 v84, v84, v88, s[96:97]
    v_mov_b32 v85, s72
    v_lshl_add_u32 v19, v18, 3, v17
    v_lshlrev_b32 v19, 3, v19
    s_lshl_b32 s39, s85, 9
    s_add_u32 s39, s39, 2883584
    buffer_store_dwordx2 v[84:85], v19, s[52:55], s39 offen sc1
no_lp:
    s_add_u32 s39, s34, 172032
    buffer_load_dwordx4 v[116:119], v245, s[56:59], s39 offen
    s_add_u32 s39, s34, 172928
    buffer_load_dwordx4 v[120:123], v245, s[56:59], s39 offen
    s_add_u32 s39, s34, 173824
    buffer_load_dwordx4 v[124:127], v245, s[56:59], s39 offen
    s_add_u32 s39, s34, 344064
    buffer_load_dwordx4 v[128:131], v245, s[56:59], s39 offen
    s_add_u32 s39, s34, 344960
    buffer_load_dwordx4 v[132:135], v245, s[56:59], s39 offen
    s_add_u32 s39, s34, 345856
    buffer_load_dwordx4 v[136:139], v245, s[56:59], s39 offen
    s_waitcnt vmcnt(9)
nw0_1:
    s_cmp_eq_u32 s24, 0
    s_cbranch_scc1 w0_2
    s_cmp_ge_u32 s43, 18
    s_cselect_b32 s42, 18, 0
    s_sub_u32 s43, s43, s42
    s_lshl_b32 s88, s43, 10
    s_mul_i32 s89, s43, 7168
    s_add_u32 s89, s89, s41
    s_add_u32 s43, s43, 1
    s_add_u32 m0, s88, 0
    s_add_u32 s39, s89, 0
    buffer_load_dwordx4 v24, s[48:51], s39 offen nt lds
    s_add_u32 m0, s88, 18688
    s_add_u32 s39, s89, 128
    buffer_load_dwordx4 v24, s[48:51], s39 offen nt lds
    s_add_u32 m0, s88, 37376
    s_add_u32 s39, s89, 256
    buffer_load_dwordx4 v24, s[48:51], s39 offen nt lds
    s_add_u32 m0, s88, 56064
    s_add_u32 s39, s89, 384
    buffer_load_dwordx4 v24, s[48:51], s39 offen nt lds
    s_add_u32 m0, s88, 74752
    s_add_u32 s39, s89, 512
    buffer_load_dwordx4 v24, s[48:51], s39 offen nt lds
    s_add_u32 m0, s88, 93440
    s_add_u32 s39, s89, 640
    buffer_load_dwordx4 v24, s[48:51], s39 offen nt lds
    s_add_u32 m0, s88, 112128
    s_add_u32 s39, s89, 768
    buffer_load_dwordx4 v24, s[48:51], s39 offen nt lds
    s_cmp_ge_u32 s43, 18
    s_cselect_b32 s42, 18, 0
    s_sub_u32 s43, s43, s42
    s_lshl_b32 s88, s43, 10
    s_mul_i32 s89, s43, 7168
    s_add_u32 s89, s89, s41
    s_add_u32 s43, s43, 1
    s_add_u32 m0, s88, 0
    s_add_u32 s39, s89, 0
    buffer_load_dwordx4 v25, s[48:51], s39 offen nt lds
    s_add_u32 m0, s88, 18688
    s_add_u32 s39, s89, 128
    buffer_load_dwordx4 v25, s[48:51], s39 offen nt lds
    s_add_u32 m0, s88, 37376
    s_add_u32 s39, s89, 256
    buffer_load_dwordx4 v25, s[48:51], s39 offen nt lds
    s_add_u32 m0, s88, 56064
    s_add_u32 s39, s89, 384
    buffer_load_dwordx4 v25, s[48:51], s39 offen nt lds
    s_add_u32 m0, s88, 74752
    s_add_u32 s39, s89, 512
    buffer_load_dwordx4 v25, s[48:51], s39 offen nt lds
    s_add_u32 m0, s88, 93440
    s_add_u32 s39, s89, 640
    buffer_load_dwordx4 v25, s[48:51], s39 offen nt lds
    s_add_u32 m0, s88, 112128
    s_add_u32 s39, s89, 768
    buffer_load_dwordx4 v25, s[48:51], s39 offen nt lds
    s_cmp_ge_u32 s43, 18
    s_cselect_b32 s42, 18, 0
    s_sub_u32 s43, s43, s42
    s_lshl_b32 s88, s43, 10
    s_mul_i32 s89, s43, 7168
    s_add_u32 s89, s89, s41
    s_add_u32 s43, s43, 1
    s_waitcnt vmcnt(14)
    s_add_u32 m0, s88, 0
    s_add_u32 s39, s89, 0
    buffer_load_dwordx4 v24, s[48:51], s39 offen nt lds
    s_add_u32 m0, s88, 18688
    s_add_u32 s39, s89, 128
    buffer_load_dwordx4 v24, s[48:51], s39 offen nt lds
    s_add_u32 m0, s88, 37376
    s_add_u32 s39, s89, 256
    buffer_load_dwordx4 v24, s[48:51], s39 offen nt lds
    s_add_u32 m0, s88, 56064
    s_add_u32 s39, s89, 384
    buffer_load_dwordx4 v24, s[48:51], s39 offen nt lds
    s_add_u32 m0, s88, 74752
    s_add_u32 s39, s89, 512
    buffer_load_dwordx4 v24, s[48:51], s39 offen nt lds
    s_add_u32 m0, s88, 93440
    s_add_u32 s39, s89, 640
    buffer_load_dwordx4 v24, s[48:51], s39 offen nt lds
    s_add_u32 m0, s88, 112128
    s_add_u32 s39, s89, 768
    buffer_load_dwordx4 v24, s[48:51], s39 offen nt lds
    s_cmp_ge_u32 s43, 18
    s_cselect_b32 s42, 18, 0
    s_sub_u32 s43, s43, s42
    s_lshl_b32 s88, s43, 10
    s_mul_i32 s89, s43, 7168
    s_add_u32 s89, s89, s41
    s_add_u32 s43, s43, 1
    s_waitcnt vmcnt(14)
    s_add_u32 m0, s88, 0
    s_add_u32 s39, s89, 0
    buffer_load_dwordx4 v25, s[48:51], s39 offen nt lds
    s_add_u32 m0, s88, 18688
    s_add_u32 s39, s89, 128
    buffer_load_dwordx4 v25, s[48:51], s39 offen nt lds
    s_add_u32 m0, s88, 37376
    s_add_u32 s39, s89, 256
    buffer_load_dwordx4 v25, s[48:51], s39 offen nt lds
    s_add_u32 m0, s88, 56064
    s_add_u32 s39, s89, 384
    buffer_load_dwordx4 v25, s[48:51], s39 offen nt lds
    s_add_u32 m0, s88, 74752
    s_add_u32 s39, s89, 512
    buffer_load_dwordx4 v25, s[48:51], s39 offen nt lds
    s_add_u32 m0, s88, 93440
    s_add_u32 s39, s89, 640
    buffer_load_dwordx4 v25, s[48:51], s39 offen nt lds
    s_add_u32 m0, s88, 112128
    s_add_u32 s39, s89, 768
    buffer_load_dwordx4 v25, s[48:51], s39 offen nt lds
    s_cmp_lg_u32 s24, 3
    s_cbranch_scc1 xq_done
    s_cmp_ge_u32 s43, 18
    s_cselect_b32 s42, 18, 0
    s_sub_u32 s43, s43, s42
    s_lshl_b32 s88, s43, 10
    s_mul_i32 s89, s43, 7168
    s_add_u32 s89, s89, s41
    s_add_u32 s43, s43, 1
    s_waitcnt vmcnt(14)
    s_add_u32 m0, s88, 0
    s_add_u32 s39, s89, 0
    buffer_load_dwordx4 v24, s[48:51], s39 offen nt lds
    s_add_u32 m0, s88, 18688
    s_add_u32 s39, s89, 128
    buffer_load_dwordx4 v24, s[48:51], s39 offen nt lds
    s_add_u32 m0, s88, 37376
    s_add_u32 s39, s89, 256
    buffer_load_dwordx4 v24, s[48:51], s39 offen nt lds
    s_add_u32 m0, s88, 56064
    s_add_u32 s39, s89, 384
    buffer_load_dwordx4 v24, s[48:51], s39 offen nt lds
    s_add_u32 m0, s88, 74752
    s_add_u32 s39, s89, 512
    buffer_load_dwordx4 v24, s[48:51], s39 offen nt lds
    s_add_u32 m0, s88, 93440
    s_add_u32 s39, s89, 640
    buffer_load_dwordx4 v24, s[48:51], s39 offen nt lds
    s_add_u32 m0, s88, 112128
    s_add_u32 s39, s89, 768
    buffer_load_dwordx4 v24, s[48:51], s39 offen nt lds
    s_cmp_ge_u32 s43, 18
    s_cselect_b32 s42, 18, 0
    s_sub_u32 s43, s43, s42
    s_lshl_b32 s88, s43, 10
    s_mul_i32 s89, s43, 7168
    s_add_u32 s89, s89, s41
    s_add_u32 s43, s43, 1
    s_waitcnt vmcnt(14)
    s_add_u32 m0, s88, 0
    s_add_u32 s39, s89, 0
    buffer_load_dwordx4 v25, s[48:51], s39 offen nt lds
    s_add_u32 m0, s88, 18688
    s_add_u32 s39, s89, 128
    buffer_load_dwordx4 v25, s[48:51], s39 offen nt lds
    s_add_u32 m0, s88, 37376
    s_add_u32 s39, s89, 256
    buffer_load_dwordx4 v25, s[48:51], s39 offen nt lds
    s_add_u32 m0, s88, 56064
    s_add_u32 s39, s89, 384
    buffer_load_dwordx4 v25, s[48:51], s39 offen nt lds
    s_add_u32 m0, s88, 74752
    s_add_u32 s39, s89, 512
    buffer_load_dwordx4 v25, s[48:51], s39 offen nt lds
    s_add_u32 m0, s88, 93440
    s_add_u32 s39, s89, 640
    buffer_load_dwordx4 v25, s[48:51], s39 offen nt lds
    s_add_u32 m0, s88, 112128
    s_add_u32 s39, s89, 768
    buffer_load_dwordx4 v25, s[48:51], s39 offen nt lds
xq_done:
    v_readfirstlane_b32 s72, v16
    s_nop 0
    s_add_u32 s72, s72, 16
    s_add_u32 s39, s34, 0
    buffer_load_dwordx4 v[104:107], v245, s[56:59], s39 offen
    s_add_u32 s39, s34, 896
    buffer_load_dwordx4 v[108:111], v245, s[56:59], s39 offen
    s_add_u32 s39, s34, 1792
    buffer_load_dwordx4 v[112:115], v245, s[56:59], s39 offen
    s_add_u32 s39, s34, 172032
    buffer_load_dwordx4 v[116:119], v245, s[56:59], s39 offen
    s_add_u32 s39, s34, 172928
    buffer_load_dwordx4 v[120:123], v245, s[56:59], s39 offen
    s_add_u32 s39, s34, 173824
    buffer_load_dwordx4 v[124:127], v245, s[56:59], s39 offen
    s_cmp_eq_u32 s24, 3
    s_cbranch_scc1 tg_skip1
    v_lshlrev_b32 v30, 3, v1
    s_lshl_b32 s75, s27, 14
    s_add_u32 s75, s75, 262144
    s_sub_u32 s78, s24, 1
    s_lshl_b32 s74, s78, 12
    s_add_u32 s74, s74, s75
    s_mul_i32 s76, s78, 3072
    s_add_u32 s76, s76, 3072
    s_add_u32 s76, s76, s75
    s_add_u32 s75, s74, 7168
    s_add_u32 s77, s76, 7168
    buffer_load_dwordx2 v[200:201], v30, s[52:55], s74 offen offset:0 sc1
    buffer_load_dwordx2 v[202:203], v30, s[52:55], s74 offen offset:512 sc1
    buffer_load_dwordx2 v[204:205], v30, s[52:55], s75 offen offset:0 sc1
    buffer_load_dwordx2 v[206:207], v30, s[52:55], s75 offen offset:512 sc1
    buffer_load_dwordx2 v[208:209], v30, s[52:55], s74 offen offset:1024 sc1
    buffer_load_dwordx2 v[210:211], v30, s[52:55], s74 offen offset:1536 sc1
    buffer_load_dwordx2 v[212:213], v30, s[52:55], s75 offen offset:1024 sc1
    buffer_load_dwordx2 v[214:215], v30, s[52:55], s75 offen offset:1536 sc1
    buffer_load_dwordx2 v[216:217], v30, s[52:55], s74 offen offset:2048 sc1
    buffer_load_dwordx2 v[218:219], v30, s[52:55], s74 offen offset:2560 sc1
    buffer_load_dwordx2 v[220:221], v30, s[52:55], s75 offen offset:2048 sc1
    buffer_load_dwordx2 v[222:223], v30, s[52:55], s75 offen offset:2560 sc1
    buffer_load_dwordx2 v[224:225], v30, s[52:55], s76 offen offset:0 sc1
    buffer_load_dwordx2 v[226:227], v30, s[52:55], s76 offen offset:512 sc1
    buffer_load_dwordx2 v[228:229], v30, s[52:55], s77 offen offset:0 sc1
    buffer_load_dwordx2 v[230:231], v30, s[52:55], s77 offen offset:512 sc1
tg_skip1:
    s_add_u32 s39, s34, 344064
    buffer_load_dwordx4 v[128:131], v245, s[56:59], s39 offen
    s_add_u32 s39, s34, 344960
    buffer_load_dwordx4 v[132:135], v245, s[56:59], s39 offen
    s_add_u32 s39, s34, 345856
    buffer_load_dwordx4 v[136:139], v245, s[56:59], s39 offen
    s_cmp_eq_u32 s24, 3
    s_cbranch_scc1 tg_skip2
    s_lshl_b32 s47, s78, 10
    s_add_u32 s47, s47, 155392
    v_lshl_add_u32 v92, v1, 2, s47
    s_mul_i32 s47, s78, 768
    s_add_u32 s47, s47, 156160
    v_lshl_add_u32 v93, v1, 2, s47
    v_xor_b32 v94, 1, v17
    v_lshlrev_b32 v94, 4, v94
    v_lshl_add_u32 v94, v18, 1, v94
    s_mul_i32 s47, s78, 56064
    s_add_u32 s47, s47, 74624
    v_add_u32 v95, s47, v94
    s_mul_i32 s47, s78, 74752
    s_add_u32 s47, s47, 18560
    v_add_u32 v94, s47, v94
    v_mov_b32 v96, 0x2b800000
    s_mov_b32 s47, 0
    s_waitcnt vmcnt(3)
tg_checka:
    s_add_u32 s47, s47, 1
    v_xor_b32 v201, s72, v201
    v_xor_b32 v203, s72, v203
    v_xor_b32 v205, s72, v205
    v_xor_b32 v207, s72, v207
    v_xor_b32 v209, s72, v209
    v_xor_b32 v211, s72, v211
    v_xor_b32 v213, s72, v213
    v_xor_b32 v215, s72, v215
    v_xor_b32 v217, s72, v217
    v_xor_b32 v219, s72, v219
    v_xor_b32 v221, s72, v221
    v_xor_b32 v223, s72, v223
    v_xor_b32 v225, s72, v225
    v_xor_b32 v227, s72, v227
    v_xor_b32 v229, s72, v229
    v_xor_b32 v231, s72, v231
    v_or3_b32 v203, v203, v205, v207
    v_or3_b32 v209, v209, v211, v213
    v_or3_b32 v215, v215, v217, v219
    v_or3_b32 v221, v221, v223, v225
    v_or3_b32 v227, v227, v229, v231
    v_or3_b32 v201, v201, v203, v209
    v_or3_b32 v215, v215, v221, v227
    v_or_b32 v201, v201, v215
    v_cmp_ne_u32 vcc, 0, v201
    s_cmp_gt_u32 s47, 200000
    s_cbranch_scc1 tg_donea
    s_cbranch_vccz tg_donea
    buffer_load_dwordx2 v[200:201], v30, s[52:55], s74 offen offset:0 sc1
    buffer_load_dwordx2 v[202:203], v30, s[52:55], s74 offen offset:512 sc1
    buffer_load_dwordx2 v[204:205], v30, s[52:55], s75 offen offset:0 sc1
    buffer_load_dwordx2 v[206:207], v30, s[52:55], s75 offen offset:512 sc1
    buffer_load_dwordx2 v[208:209], v30, s[52:55], s74 offen offset:1024 sc1
    buffer_load_dwordx2 v[210:211], v30, s[52:55], s74 offen offset:1536 sc1
    buffer_load_dwordx2 v[212:213], v30, s[52:55], s75 offen offset:1024 sc1
    buffer_load_dwordx2 v[214:215], v30, s[52:55], s75 offen offset:1536 sc1
    buffer_load_dwordx2 v[216:217], v30, s[52:55], s74 offen offset:2048 sc1
    buffer_load_dwordx2 v[218:219], v30, s[52:55], s74 offen offset:2560 sc1
    buffer_load_dwordx2 v[220:221], v30, s[52:55], s75 offen offset:2048 sc1
    buffer_load_dwordx2 v[222:223], v30, s[52:55], s75 offen offset:2560 sc1
    buffer_load_dwordx2 v[224:225], v30, s[52:55], s76 offen offset:0 sc1
    buffer_load_dwordx2 v[226:227], v30, s[52:55], s76 offen offset:512 sc1
    buffer_load_dwordx2 v[228:229], v30, s[52:55], s77 offen offset:0 sc1
    buffer_load_dwordx2 v[230:231], v30, s[52:55], s77 offen offset:512 sc1
    s_waitcnt vmcnt(0)
    s_branch tg_checka
tg_donea:
    v_add_f32 v200, v200, v202
    v_add_f32 v204, v204, v206
    v_add_f32 v208, v208, v210
    v_add_f32 v212, v212, v214
    v_add_f32 v216, v216, v218
    v_add_f32 v220, v220, v222
    v_add_f32 v224, v224, v226
    v_add_f32 v228, v228, v230
    v_cvt_pk_bf16_f32 v201, v200, v204
    v_cvt_pk_bf16_f32 v209, v208, v212
    v_cvt_pk_bf16_f32 v217, v216, v220
    v_cvt_pk_bf16_f32 v225, v224, v228
    v_lshlrev_b32 v236, 16, v201
    v_and_b32 v232, 0xffff0000, v201
    v_lshlrev_b32 v237, 16, v209
    v_and_b32 v233, 0xffff0000, v209
    v_lshlrev_b32 v238, 16, v217
    v_and_b32 v234, 0xffff0000, v217
    v_lshlrev_b32 v239, 16, v225
    v_and_b32 v235, 0xffff0000, v225
    v_add_f32 v232, 1.0, v232
    v_add_f32 v233, 1.0, v233
    v_add_f32 v234, 1.0, v234
    v_add_f32 v235, 1.0, v235
    v_cvt_pk_bf16_f32 v232, v232, v232
    v_lshlrev_b32 v232, 16, v232
    v_cvt_pk_bf16_f32 v233, v233, v233
    v_lshlrev_b32 v233, 16, v233
    v_cvt_pk_bf16_f32 v234, v234, v234
    v_lshlrev_b32 v234, 16, v234
    v_cvt_pk_bf16_f32 v235, v235, v235
    v_lshlrev_b32 v235, 16, v235
    v_cmp_eq_f32 vcc, 0, v232
    s_nop 1
    v_cndmask_b32 v232, v232, v96, vcc
    v_cmp_eq_f32 vcc, 0, v233
    s_nop 1
    v_cndmask_b32 v233, v233, v96, vcc
    v_cmp_eq_f32 vcc, 0, v234
    s_nop 1
    v_cndmask_b32 v234, v234, v96, vcc
    v_cmp_eq_f32 vcc, 0, v235
    s_nop 1
    v_cndmask_b32 v235, v235, v96, vcc
    ds_write_b32 v92, v232 offset:0
    ds_write_b32 v92, v233 offset:256
    ds_write_b32 v92, v234 offset:512
    ds_write_b32 v93, v235 offset:0
    v_rcp_f32 v240, v232
    v_rcp_f32 v241, v233
    v_rcp_f32 v242, v234
    v_rcp_f32 v243, v235
    v_mul_f32 v240, v240, v236
    v_mul_f32 v241, v241, v237
    v_mul_f32 v242, v242, v238
    v_mul_f32 v243, v243, v239
    v_cvt_pk_bf16_f32 v240, v240, v240
    v_cvt_pk_bf16_f32 v241, v241, v241
    v_cvt_pk_bf16_f32 v242, v242, v242
    v_cvt_pk_bf16_f32 v243, v243, v243
    ds_write_b16 v94, v240 offset:0
    ds_write_b16 v94, v241 offset:18688
    ds_write_b16 v94, v242 offset:37376
    ds_write_b16 v95, v243 offset:0
    s_waitcnt lgkmcnt(0)
tg_skip2:
w0_2:
    s_sub_u32 s85, s2, 112
    v_and_b32 v6, 7, v2
    v_xor_b32 v6, v6, v3
    v_lshlrev_b32 v6, 4, v6
    s_lshl_b32 s39, s30, 6
    s_add_u32 s39, s39, s29
    s_add_u32 s39, s39, 16
    v_lshl_add_u32 v5, v2, 1, s39
    v_subrev_u32 v16, 32, v5
    v_add_u32 v17, 16, v16
    v_cmp_gt_i32 vcc, 0, v16
    s_nop 1
    v_cndmask_b32 v16, v16, v17, vcc
    v_add_u32 v17, 144, v2
    v_cmp_gt_u32 vcc, 2, v2
    s_nop 1
    v_cndmask_b32 v16, v16, v17, vcc
    v_lshl_add_u32 v16, v16, 7, v6
    v_xor_b32 v17, 64, v16
    v_lshl_add_u32 v5, v5, 7, v6
    v_xor_b32 v6, 64, v5
    v_lshrrev_b32 v8, 2, v2
    v_lshl_add_u32 v8, v3, 3, v8
    v_lshlrev_b32 v8, 6, v8
    v_and_b32 v9, 3, v2
    v_lshl_add_u32 v8, v9, 3, v8
    v_and_b32 v9, 1, v3
    v_lshl_add_u32 v8, v9, 5, v8
    v_xor_b32 v9, 32, v8
    v_add_u32 v8, 130816, v8
    v_add_u32 v9, 130816, v9
    s_and_b32 s39, s28, 1
    s_lshl_b32 s40, s27, 1
    s_add_u32 s40, s40, s39
    s_lshr_b32 s41, s28, 1
    s_lshl_b32 s42, s41, 7
    v_lshrrev_b32 v7, 3, v1
    s_movk_i32 s33, 896
    v_mul_lo_u32 v7, v7, s33
    v_bfe_u32 v15, v1, 4, 1
    s_lshl_b32 s33, s29, 1
    v_or_b32 v15, s33, v15
    v_lshlrev_b32 v15, 1, v15
    v_and_b32 v18, 7, v1
    v_xor_b32 v18, v18, v15
    v_lshl_add_u32 v7, v18, 4, v7
    s_mov_b32 s60, s8
    s_and_b32 s61, s9, 0xffff
    s_mov_b32 s62, 0x62000
    s_mov_b32 s63, 0x20000
    s_mov_b32 s64, s12
    s_and_b32 s65, s13, 0xffff
    s_mov_b32 s66, 0x188000
    s_mov_b32 s67, 0x20000
    s_mov_b32 s92, s14
    s_and_b32 s93, s15, 0xffff
    s_mov_b32 s94, 0x188000
    s_mov_b32 s95, 0x20000
    v_and_b32 v14, 1, v3
    v_lshrrev_b32 v15, 1, v3
    v_lshl_add_u32 v14, v14, 1, v15
    v_lshlrev_b32 v14, 8, v14
    v_lshl_add_u32 v14, v2, 4, v14
    s_lshr_b32 s100, s31, 4
    s_add_u32 s100, s100, s29
    s_lshl_b32 s100, s100, 14
    s_lshl_b32 s39, s28, 10
    s_add_u32 s100, s100, s39
    s_add_u32 s100, s100, 3145728
    s_add_u32 s101, s100, 32768
    v_cmp_eq_u32 s[76:77], 3, v3
    s_mov_b32 s96, s22
    s_and_b32 s97, s23, 0xffff
    s_mov_b32 s98, 0x10000000
    s_mov_b32 s99, 0x20000
    s_cmp_ge_u32 s28, 14
    s_cselect_b32 s98, 0, s98
    v_accvgpr_write_b32 a236, -1
    v_accvgpr_write_b32 a237, -1
    v_accvgpr_write_b32 a238, -1
    v_accvgpr_write_b32 a239, -1
    s_lshl_b32 s32, s40, 2
    s_add_u32 s32, s32, s24
    s_mul_i32 s78, s32, 14336
    s_lshl_b32 s38, s41, 11
    s_add_u32 s78, s78, s38
    s_add_u32 s78, s78, 7340032
    s_lshl_b32 s79, s32, 10
    s_add_u32 s79, s79, s42
    s_add_u32 s79, s79, 131072
    s_lshl_b32 s87, s2, 2
    s_add_u32 s87, s87, s24
    s_mul_i32 s91, s87, 392
    s_mul_i32 s87, s87, 1568
    s_mul_i32 s44, s24, 7168
    s_add_u32 s88, s44, s42
    s_lshl_b32 s89, s24, 10
    s_mov_b32 s46, 0xffff0000
    v_lshlrev_b32 v28, 3, v1
    s_cmp_lg_u32 s24, 3
    s_cbranch_scc1 b2_skip
    s_waitcnt vmcnt(9)
b2_skip:
    s_waitcnt lgkmcnt(0)
    s_barrier
    ds_read_b32 v188, v10 offset:0
    ds_read_b32 v189, v10 offset:256
    ds_read_b32 v190, v10 offset:512
    ds_read_b32 v191, v10 offset:768
    ds_read_b32 v192, v10 offset:1024
    ds_read_b32 v193, v10 offset:1280
    ds_read_b32 v194, v10 offset:1536
    s_waitcnt vmcnt(6)
    s_waitcnt lgkmcnt(0)
    v_lshrrev_b32 v195, 16, v188
    v_dot2_f32_bf16 v196, v104, v195, 0
    ds_read_b128 a[0:3], v16 offset:0
    v_dot2_f32_bf16 v197, v104, v188, 0
    v_dot2_f32_bf16 v198, v105, v195, 0
    v_dot2_f32_bf16 v199, v105, v188, 0
    v_dot2_f32_bf16 v200, v106, v195, 0
    ds_read_b128 a[4:7], v17 offset:0
    v_dot2_f32_bf16 v201, v106, v188, 0
    v_dot2_f32_bf16 v202, v107, v195, 0
    v_dot2_f32_bf16 v203, v107, v188, 0
    v_cvt_pk_bf16_f32 v104, v196, v197
    ds_read_b128 a[56:59], v5 offset:0
    v_cvt_pk_bf16_f32 v105, v198, v199
    v_cvt_pk_bf16_f32 v106, v200, v201
    v_cvt_pk_bf16_f32 v107, v202, v203
    ds_write_b128 v13, v[104:107] offset:0
    ds_read_b128 a[60:63], v6 offset:0
    v_dot2_f32_bf16 v204, v108, v195, 0
    v_dot2_f32_bf16 v205, v108, v188, 0
    v_dot2_f32_bf16 v206, v109, v195, 0
    v_dot2_f32_bf16 v207, v109, v188, 0
    ds_read_b128 a[112:115], v5 offset:4096
    v_dot2_f32_bf16 v208, v110, v195, 0
    v_dot2_f32_bf16 v209, v110, v188, 0
    v_dot2_f32_bf16 v210, v111, v195, 0
    v_dot2_f32_bf16 v211, v111, v188, 0
    ds_read_b128 a[116:119], v6 offset:4096
    v_cvt_pk_bf16_f32 v108, v204, v205
    v_cvt_pk_bf16_f32 v109, v206, v207
    v_cvt_pk_bf16_f32 v110, v208, v209
    v_cvt_pk_bf16_f32 v111, v210, v211
    ds_read_b128 a[8:11], v16 offset:18688
    ds_write_b128 v13, v[108:111] offset:2048
    v_dot2_f32_bf16 v212, v112, v195, 0
    v_dot2_f32_bf16 v213, v112, v188, 0
    v_dot2_f32_bf16 v214, v113, v195, 0
    ds_read_b128 a[12:15], v17 offset:18688
    v_dot2_f32_bf16 v215, v113, v188, 0
    v_dot2_f32_bf16 v216, v114, v195, 0
    v_dot2_f32_bf16 v217, v114, v188, 0
    v_dot2_f32_bf16 v218, v115, v195, 0
    ds_read_b128 a[64:67], v5 offset:18688
    v_dot2_f32_bf16 v219, v115, v188, 0
    v_cvt_pk_bf16_f32 v112, v212, v213
    v_cvt_pk_bf16_f32 v113, v214, v215
    v_cvt_pk_bf16_f32 v114, v216, v217
    ds_read_b128 a[68:71], v6 offset:18688
    v_cvt_pk_bf16_f32 v115, v218, v219
    ds_write_b128 v13, v[112:115] offset:4096
    s_waitcnt vmcnt(3)
    v_lshrrev_b32 v195, 16, v189
    ds_read_b128 a[120:123], v5 offset:22784
    v_dot2_f32_bf16 v196, v116, v195, 0
    v_dot2_f32_bf16 v197, v116, v189, 0
    v_dot2_f32_bf16 v198, v117, v195, 0
    v_dot2_f32_bf16 v199, v117, v189, 0
    ds_read_b128 a[124:127], v6 offset:22784
    v_dot2_f32_bf16 v200, v118, v195, 0
    v_dot2_f32_bf16 v201, v118, v189, 0
    v_dot2_f32_bf16 v202, v119, v195, 0
    v_dot2_f32_bf16 v203, v119, v189, 0
    v_cvt_pk_bf16_f32 v116, v196, v197
    v_cvt_pk_bf16_f32 v117, v198, v199
    v_cvt_pk_bf16_f32 v118, v200, v201
    v_cvt_pk_bf16_f32 v119, v202, v203
    s_waitcnt lgkmcnt(10)
    ds_write_b128 v13, v[116:119] offset:12288
    v_dot2_f32_bf16 v204, v120, v195, 0
    v_dot2_f32_bf16 v205, v120, v189, 0
    v_dot2_f32_bf16 v206, v121, v195, 0
    v_dot2_f32_bf16 v207, v121, v189, 0
    v_dot2_f32_bf16 v208, v122, v195, 0
    v_dot2_f32_bf16 v209, v122, v189, 0
    v_dot2_f32_bf16 v210, v123, v195, 0
    v_dot2_f32_bf16 v211, v123, v189, 0
    v_cvt_pk_bf16_f32 v120, v204, v205
    v_cvt_pk_bf16_f32 v121, v206, v207
    v_cvt_pk_bf16_f32 v122, v208, v209
    v_cvt_pk_bf16_f32 v123, v210, v211
    ds_write_b128 v13, v[120:123] offset:14336
    v_dot2_f32_bf16 v212, v124, v195, 0
    v_dot2_f32_bf16 v213, v124, v189, 0
    v_dot2_f32_bf16 v214, v125, v195, 0
    v_dot2_f32_bf16 v215, v125, v189, 0
    v_dot2_f32_bf16 v216, v126, v195, 0
    v_dot2_f32_bf16 v217, v126, v189, 0
    v_dot2_f32_bf16 v218, v127, v195, 0
    v_dot2_f32_bf16 v219, v127, v189, 0
    v_cvt_pk_bf16_f32 v124, v212, v213
    v_cvt_pk_bf16_f32 v125, v214, v215
    v_cvt_pk_bf16_f32 v126, v216, v217
    v_cvt_pk_bf16_f32 v127, v218, v219
    ds_write_b128 v13, v[124:127] offset:16384
    v_add_u32 v13, 74752, v12
    s_waitcnt lgkmcnt(0)
    s_barrier
    ds_read_b64_tr_b16 a[168:169], v8 offset:0
    ds_read_b64_tr_b16 a[170:171], v8 offset:256
    ds_read_b64_tr_b16 a[172:173], v9 offset:0
    ds_read_b64_tr_b16 a[174:175], v9 offset:256
    ds_read_b64_tr_b16 a[176:177], v8 offset:2048
    ds_read_b64_tr_b16 a[178:179], v8 offset:2304
    ds_read_b64_tr_b16 a[180:181], v9 offset:2048
    ds_read_b64_tr_b16 a[182:183], v9 offset:2304
    ds_read_b64_tr_b16 a[184:185], v8 offset:4096
    ds_read_b64_tr_b16 a[186:187], v8 offset:4352
    ds_read_b64_tr_b16 a[188:189], v9 offset:4096
    ds_read_b64_tr_b16 a[190:191], v9 offset:4352
    s_waitcnt lgkmcnt(0)
    v_mfma_f32_16x16x32_bf16 v[32:35], a[168:171], a[0:3], 0
    s_add_u32 s39, s34, 516096
    buffer_load_dwordx4 v[140:143], v245, s[56:59], s39 offen
    s_add_u32 s39, s34, 516992
    buffer_load_dwordx4 v[144:147], v245, s[56:59], s39 offen
    s_add_u32 s39, s34, 517888
    buffer_load_dwordx4 v[148:151], v245, s[56:59], s39 offen
    v_mfma_f32_16x16x32_bf16 v[56:59], a[168:171], a[56:59], 0
    ds_read_b64_tr_b16 a[192:193], v8 offset:6144
    ds_read_b64_tr_b16 a[194:195], v8 offset:6400
    ds_read_b64_tr_b16 a[196:197], v9 offset:6144
    v_mfma_f32_16x16x32_bf16 v[80:83], a[168:171], a[112:115], 0
    ds_read_b64_tr_b16 a[198:199], v9 offset:6400
    ds_read_b64_tr_b16 a[200:201], v8 offset:8192
    ds_read_b64_tr_b16 a[202:203], v8 offset:8448
    v_mfma_f32_16x16x32_bf16 v[36:39], a[172:175], a[0:3], 0
    ds_read_b64_tr_b16 a[204:205], v9 offset:8192
    ds_read_b64_tr_b16 a[206:207], v9 offset:8448
    ds_read_b64_tr_b16 a[208:209], v8 offset:10240
    v_mfma_f32_16x16x32_bf16 v[60:63], a[172:175], a[56:59], 0
    ds_read_b64_tr_b16 a[210:211], v8 offset:10496
    ds_read_b64_tr_b16 a[212:213], v9 offset:10240
    ds_read_b64_tr_b16 a[214:215], v9 offset:10496
    v_mfma_f32_16x16x32_bf16 v[84:87], a[172:175], a[112:115], 0
    s_waitcnt vmcnt(3)
    v_lshlrev_b32 v196, 16, v128
    v_and_b32 v197, s46, v128
    v_mfma_f32_16x16x32_bf16 v[40:43], a[176:179], a[0:3], 0
    v_lshlrev_b32 v198, 16, v129
    v_and_b32 v199, s46, v129
    v_lshlrev_b32 v200, 16, v130
    v_mfma_f32_16x16x32_bf16 v[64:67], a[176:179], a[56:59], 0
    v_and_b32 v201, s46, v130
    v_lshlrev_b32 v202, 16, v131
    v_and_b32 v203, s46, v131
    v_mfma_f32_16x16x32_bf16 v[88:91], a[176:179], a[112:115], 0
    v_mul_f32 v196, v190, v196
    v_mul_f32 v197, v190, v197
    v_mul_f32 v198, v190, v198
    v_mfma_f32_16x16x32_bf16 v[44:47], a[180:183], a[0:3], 0
    v_mul_f32 v199, v190, v199
    v_mul_f32 v200, v190, v200
    v_mul_f32 v201, v190, v201
    v_mfma_f32_16x16x32_bf16 v[68:71], a[180:183], a[56:59], 0
    v_mul_f32 v202, v190, v202
    v_mul_f32 v203, v190, v203
    v_cvt_pk_bf16_f32 v128, v196, v197
    v_mfma_f32_16x16x32_bf16 v[92:95], a[180:183], a[112:115], 0
    v_cvt_pk_bf16_f32 v129, v198, v199
    v_cvt_pk_bf16_f32 v130, v200, v201
    v_cvt_pk_bf16_f32 v131, v202, v203
    v_mfma_f32_16x16x32_bf16 v[48:51], a[0:3], a[184:187], 0
    ds_write_b128 v12, v[128:131] offset:0
    v_lshlrev_b32 v204, 16, v132
    v_and_b32 v205, s46, v132
    v_mfma_f32_16x16x32_bf16 v[72:75], a[56:59], a[184:187], 0
    v_lshlrev_b32 v206, 16, v133
    v_and_b32 v207, s46, v133
    v_lshlrev_b32 v208, 16, v134
    v_mfma_f32_16x16x32_bf16 v[96:99], a[112:115], a[184:187], 0
    v_and_b32 v209, s46, v134
    v_lshlrev_b32 v210, 16, v135
    v_and_b32 v211, s46, v135
    v_mfma_f32_16x16x32_bf16 v[52:55], a[0:3], a[188:191], 0
    v_mul_f32 v204, v190, v204
    v_mul_f32 v205, v190, v205
    v_mul_f32 v206, v190, v206
    v_mfma_f32_16x16x32_bf16 v[76:79], a[56:59], a[188:191], 0
    v_mul_f32 v207, v190, v207
    v_mul_f32 v208, v190, v208
    v_mul_f32 v209, v190, v209
    v_mfma_f32_16x16x32_bf16 v[100:103], a[112:115], a[188:191], 0
    v_mul_f32 v210, v190, v210
    v_mul_f32 v211, v190, v211
    v_cvt_pk_bf16_f32 v132, v204, v205
    v_cvt_pk_bf16_f32 v133, v206, v207
    v_cvt_pk_bf16_f32 v134, v208, v209
    v_cvt_pk_bf16_f32 v135, v210, v211
    s_waitcnt lgkmcnt(1)
    v_mfma_f32_16x16x32_bf16 v[32:35], a[192:195], a[4:7], v[32:35]
    ds_read_b64_tr_b16 a[168:169], v8 offset:12288
    ds_read_b64_tr_b16 a[170:171], v8 offset:12544
    ds_read_b64_tr_b16 a[172:173], v9 offset:12288
    v_mfma_f32_16x16x32_bf16 v[56:59], a[192:195], a[60:63], v[56:59]
    ds_read_b64_tr_b16 a[174:175], v9 offset:12544
    ds_read_b64_tr_b16 a[176:177], v8 offset:14336
    ds_read_b64_tr_b16 a[178:179], v8 offset:14592
    v_mfma_f32_16x16x32_bf16 v[80:83], a[192:195], a[116:119], v[80:83]
    ds_read_b64_tr_b16 a[180:181], v9 offset:14336
    ds_read_b64_tr_b16 a[182:183], v9 offset:14592
    ds_read_b64_tr_b16 a[184:185], v8 offset:16384
    v_mfma_f32_16x16x32_bf16 v[36:39], a[196:199], a[4:7], v[36:39]
    ds_read_b64_tr_b16 a[186:187], v8 offset:16640
    ds_read_b64_tr_b16 a[188:189], v9 offset:16384
    ds_read_b64_tr_b16 a[190:191], v9 offset:16640
    v_mfma_f32_16x16x32_bf16 v[60:63], a[196:199], a[60:63], v[60:63]
    ds_write_b128 v12, v[132:135] offset:2048
    v_lshlrev_b32 v212, 16, v136
    v_and_b32 v213, s46, v136
    v_mfma_f32_16x16x32_bf16 v[84:87], a[196:199], a[116:119], v[84:87]
    v_lshlrev_b32 v214, 16, v137
    v_and_b32 v215, s46, v137
    v_lshlrev_b32 v216, 16, v138
    v_mfma_f32_16x16x32_bf16 v[40:43], a[200:203], a[4:7], v[40:43]
    v_and_b32 v217, s46, v138
    v_lshlrev_b32 v218, 16, v139
    v_and_b32 v219, s46, v139
    v_mfma_f32_16x16x32_bf16 v[64:67], a[200:203], a[60:63], v[64:67]
    v_mul_f32 v212, v190, v212
    v_mul_f32 v213, v190, v213
    v_mul_f32 v214, v190, v214
    v_mfma_f32_16x16x32_bf16 v[88:91], a[200:203], a[116:119], v[88:91]
    v_mul_f32 v215, v190, v215
    v_mul_f32 v216, v190, v216
    v_mul_f32 v217, v190, v217
    v_mfma_f32_16x16x32_bf16 v[44:47], a[204:207], a[4:7], v[44:47]
    v_mul_f32 v218, v190, v218
    v_mul_f32 v219, v190, v219
    v_cvt_pk_bf16_f32 v136, v212, v213
    v_mfma_f32_16x16x32_bf16 v[68:71], a[204:207], a[60:63], v[68:71]
    v_cvt_pk_bf16_f32 v137, v214, v215
    v_cvt_pk_bf16_f32 v138, v216, v217
    v_cvt_pk_bf16_f32 v139, v218, v219
    v_mfma_f32_16x16x32_bf16 v[92:95], a[204:207], a[116:119], v[92:95]
    ds_write_b128 v12, v[136:139] offset:4096
    s_waitcnt lgkmcnt(10)
    ds_read_b128 a[16:19], v16 offset:37376
    ds_read_b128 a[20:23], v17 offset:37376
    v_mfma_f32_16x16x32_bf16 v[48:51], a[4:7], a[208:211], v[48:51]
    ds_read_b128 a[72:75], v5 offset:37376
    ds_read_b128 a[76:79], v6 offset:37376
    ds_read_b128 a[128:131], v5 offset:41472
    v_mfma_f32_16x16x32_bf16 v[72:75], a[60:63], a[208:211], v[72:75]
    s_waitcnt lgkmcnt(10)
    ds_read_b128 a[132:135], v6 offset:41472
    ds_read_b128 a[24:27], v16 offset:56064
    ds_read_b128 a[28:31], v17 offset:56064
    v_mfma_f32_16x16x32_bf16 v[96:99], a[116:119], a[208:211], v[96:99]
    ds_read_b128 a[80:83], v5 offset:56064
    ds_read_b128 a[84:87], v6 offset:56064
    s_waitcnt lgkmcnt(10)
    ds_read_b128 a[136:139], v5 offset:60160
    v_mfma_f32_16x16x32_bf16 v[52:55], a[4:7], a[212:215], v[52:55]
    ds_read_b128 a[140:143], v6 offset:60160
    buffer_load_dwordx4 a[232:235], v4, s[60:63], s91 offen
    v_mfma_f32_16x16x32_bf16 v[76:79], a[60:63], a[212:215], v[76:79]
    v_mfma_f32_16x16x32_bf16 v[100:103], a[116:119], a[212:215], v[100:103]
    s_barrier
    v_mfma_f32_16x16x32_bf16 v[32:35], a[168:171], a[8:11], v[32:35]
    s_add_u32 s39, s34, 688128
    buffer_load_dwordx4 v[152:155], v245, s[56:59], s39 offen
    s_add_u32 s39, s34, 689024
    buffer_load_dwordx4 v[156:159], v245, s[56:59], s39 offen
    s_add_u32 s39, s34, 689920
    buffer_load_dwordx4 v[160:163], v245, s[56:59], s39 offen
    v_mfma_f32_16x16x32_bf16 v[56:59], a[168:171], a[64:67], v[56:59]
    ds_read_b64_tr_b16 a[192:193], v8 offset:18432
    ds_read_b64_tr_b16 a[194:195], v8 offset:18688
    ds_read_b64_tr_b16 a[196:197], v9 offset:18432
    v_mfma_f32_16x16x32_bf16 v[80:83], a[168:171], a[120:123], v[80:83]
    s_waitcnt lgkmcnt(10)
    ds_read_b64_tr_b16 a[198:199], v9 offset:18688
    ds_read_b64_tr_b16 a[200:201], v8 offset:20480
    ds_read_b64_tr_b16 a[202:203], v8 offset:20736
    v_mfma_f32_16x16x32_bf16 v[36:39], a[172:175], a[8:11], v[36:39]
    ds_read_b64_tr_b16 a[204:205], v9 offset:20480
    ds_read_b64_tr_b16 a[206:207], v9 offset:20736
    s_waitcnt lgkmcnt(10)
    ds_read_b64_tr_b16 a[208:209], v8 offset:22528
    v_mfma_f32_16x16x32_bf16 v[60:63], a[172:175], a[64:67], v[60:63]
    ds_read_b64_tr_b16 a[210:211], v8 offset:22784
    ds_read_b64_tr_b16 a[212:213], v9 offset:22528
    ds_read_b64_tr_b16 a[214:215], v9 offset:22784
    v_mfma_f32_16x16x32_bf16 v[84:87], a[172:175], a[120:123], v[84:87]
    s_waitcnt vmcnt(4)
    v_lshlrev_b32 v196, 16, v140
    v_and_b32 v197, s46, v140
    v_mfma_f32_16x16x32_bf16 v[40:43], a[176:179], a[8:11], v[40:43]
    v_lshlrev_b32 v198, 16, v141
    v_and_b32 v199, s46, v141
    v_lshlrev_b32 v200, 16, v142
    v_mfma_f32_16x16x32_bf16 v[64:67], a[176:179], a[64:67], v[64:67]
    v_and_b32 v201, s46, v142
    v_lshlrev_b32 v202, 16, v143
    v_and_b32 v203, s46, v143
    v_mfma_f32_16x16x32_bf16 v[88:91], a[176:179], a[120:123], v[88:91]
    v_mul_f32 v196, v191, v196
    v_mul_f32 v197, v191, v197
    v_mul_f32 v198, v191, v198
    v_mfma_f32_16x16x32_bf16 v[44:47], a[180:183], a[8:11], v[44:47]
    v_mul_f32 v199, v191, v199
    v_mul_f32 v200, v191, v200
    v_mul_f32 v201, v191, v201
    v_mfma_f32_16x16x32_bf16 v[68:71], a[180:183], a[64:67], v[68:71]
    v_mul_f32 v202, v191, v202
    v_mul_f32 v203, v191, v203
    v_cvt_pk_bf16_f32 v140, v196, v197
    v_mfma_f32_16x16x32_bf16 v[92:95], a[180:183], a[120:123], v[92:95]
    v_cvt_pk_bf16_f32 v141, v198, v199
    v_cvt_pk_bf16_f32 v142, v200, v201
    v_cvt_pk_bf16_f32 v143, v202, v203
    v_mfma_f32_16x16x32_bf16 v[48:51], a[8:11], a[184:187], v[48:51]
    ds_write_b128 v12, v[140:143] offset:18688
    v_lshlrev_b32 v204, 16, v144
    v_and_b32 v205, s46, v144
    v_mfma_f32_16x16x32_bf16 v[72:75], a[64:67], a[184:187], v[72:75]
    v_lshlrev_b32 v206, 16, v145
    v_and_b32 v207, s46, v145
    v_lshlrev_b32 v208, 16, v146
    v_mfma_f32_16x16x32_bf16 v[96:99], a[120:123], a[184:187], v[96:99]
    v_and_b32 v209, s46, v146
    v_lshlrev_b32 v210, 16, v147
    v_and_b32 v211, s46, v147
    v_mfma_f32_16x16x32_bf16 v[52:55], a[8:11], a[188:191], v[52:55]
    v_mul_f32 v204, v191, v204
    v_mul_f32 v205, v191, v205
    v_mul_f32 v206, v191, v206
    v_mfma_f32_16x16x32_bf16 v[76:79], a[64:67], a[188:191], v[76:79]
    v_mul_f32 v207, v191, v207
    v_mul_f32 v208, v191, v208
    v_mul_f32 v209, v191, v209
    v_mfma_f32_16x16x32_bf16 v[100:103], a[120:123], a[188:191], v[100:103]
    v_mul_f32 v210, v191, v210
    v_mul_f32 v211, v191, v211
    v_cvt_pk_bf16_f32 v144, v204, v205
    v_cvt_pk_bf16_f32 v145, v206, v207
    v_cvt_pk_bf16_f32 v146, v208, v209
    v_cvt_pk_bf16_f32 v147, v210, v211
    buffer_load_dwordx4 a[232:235], v4, s[64:67], s87 offen offset:0
    s_waitcnt lgkmcnt(1)
    v_mfma_f32_16x16x32_bf16 v[32:35], a[192:195], a[12:15], v[32:35]
    v_subrev_u32 v8, 130816, v8
    v_subrev_u32 v9, 130816, v9
    ds_read_b64_tr_b16 a[168:169], v8 offset:0
    v_mfma_f32_16x16x32_bf16 v[56:59], a[192:195], a[68:71], v[56:59]
    ds_read_b64_tr_b16 a[170:171], v8 offset:256
    ds_read_b64_tr_b16 a[172:173], v9 offset:0
    ds_read_b64_tr_b16 a[174:175], v9 offset:256
    v_mfma_f32_16x16x32_bf16 v[80:83], a[192:195], a[124:127], v[80:83]
    ds_read_b64_tr_b16 a[176:177], v8 offset:2048
    ds_read_b64_tr_b16 a[178:179], v8 offset:2304
    ds_read_b64_tr_b16 a[180:181], v9 offset:2048
    v_mfma_f32_16x16x32_bf16 v[36:39], a[196:199], a[12:15], v[36:39]
    ds_read_b64_tr_b16 a[182:183], v9 offset:2304
    ds_read_b64_tr_b16 a[184:185], v8 offset:4096
    ds_read_b64_tr_b16 a[186:187], v8 offset:4352
    v_mfma_f32_16x16x32_bf16 v[60:63], a[196:199], a[68:71], v[60:63]
    ds_read_b64_tr_b16 a[188:189], v9 offset:4096
    ds_read_b64_tr_b16 a[190:191], v9 offset:4352
    ds_write_b128 v12, v[144:147] offset:20736
    v_mfma_f32_16x16x32_bf16 v[84:87], a[196:199], a[124:127], v[84:87]
    v_lshlrev_b32 v212, 16, v148
    v_and_b32 v213, s46, v148
    v_lshlrev_b32 v214, 16, v149
    v_mfma_f32_16x16x32_bf16 v[40:43], a[200:203], a[12:15], v[40:43]
    v_and_b32 v215, s46, v149
    v_lshlrev_b32 v216, 16, v150
    v_and_b32 v217, s46, v150
    v_mfma_f32_16x16x32_bf16 v[64:67], a[200:203], a[68:71], v[64:67]
    v_lshlrev_b32 v218, 16, v151
    v_and_b32 v219, s46, v151
    v_mul_f32 v212, v191, v212
    v_mfma_f32_16x16x32_bf16 v[88:91], a[200:203], a[124:127], v[88:91]
    v_mul_f32 v213, v191, v213
    v_mul_f32 v214, v191, v214
    v_mul_f32 v215, v191, v215
    v_mfma_f32_16x16x32_bf16 v[44:47], a[204:207], a[12:15], v[44:47]
    v_mul_f32 v216, v191, v216
    v_mul_f32 v217, v191, v217
    v_mul_f32 v218, v191, v218
    v_mfma_f32_16x16x32_bf16 v[68:71], a[204:207], a[68:71], v[68:71]
    v_mul_f32 v219, v191, v219
    v_cvt_pk_bf16_f32 v148, v212, v213
    v_cvt_pk_bf16_f32 v149, v214, v215
    v_mfma_f32_16x16x32_bf16 v[92:95], a[204:207], a[124:127], v[92:95]
    v_cvt_pk_bf16_f32 v150, v216, v217
    v_cvt_pk_bf16_f32 v151, v218, v219
    ds_write_b128 v12, v[148:151] offset:22784
    v_mfma_f32_16x16x32_bf16 v[48:51], a[12:15], a[208:211], v[48:51]
    v_add_u32 v5, 74752, v5
    v_add_u32 v6, 74752, v6
    v_add_u32 v16, 74752, v16
    v_mfma_f32_16x16x32_bf16 v[72:75], a[68:71], a[208:211], v[72:75]
    v_add_u32 v17, 74752, v17
    s_waitcnt lgkmcnt(10)
    ds_read_b128 a[32:35], v16 offset:0
    ds_read_b128 a[36:39], v17 offset:0
    v_mfma_f32_16x16x32_bf16 v[96:99], a[124:127], a[208:211], v[96:99]
    ds_read_b128 a[88:91], v5 offset:0
    ds_read_b128 a[92:95], v6 offset:0
    ds_read_b128 a[144:147], v5 offset:4096
    v_mfma_f32_16x16x32_bf16 v[52:55], a[12:15], a[212:215], v[52:55]
    s_waitcnt lgkmcnt(10)
    ds_read_b128 a[148:151], v6 offset:4096
    ds_read_b128 a[40:43], v16 offset:18688
    ds_read_b128 a[44:47], v17 offset:18688
    v_mfma_f32_16x16x32_bf16 v[76:79], a[68:71], a[212:215], v[76:79]
    ds_read_b128 a[96:99], v5 offset:18688
    ds_read_b128 a[100:103], v6 offset:18688
    s_waitcnt lgkmcnt(10)
    ds_read_b128 a[152:155], v5 offset:22784
    v_mfma_f32_16x16x32_bf16 v[100:103], a[124:127], a[212:215], v[100:103]
    ds_read_b128 a[156:159], v6 offset:22784
    buffer_load_dwordx4 a[232:235], v4, s[92:95], s87 offen offset:0
    s_barrier
    v_mfma_f32_16x16x32_bf16 v[32:35], a[168:171], a[16:19], v[32:35]
    s_add_u32 s39, s34, 860160
    buffer_load_dwordx4 v[164:167], v245, s[56:59], s39 offen
    s_add_u32 s39, s34, 861056
    buffer_load_dwordx4 v[168:171], v245, s[56:59], s39 offen
    s_add_u32 s39, s34, 861952
    buffer_load_dwordx4 v[172:175], v245, s[56:59], s39 offen
    v_mfma_f32_16x16x32_bf16 v[56:59], a[168:171], a[72:75], v[56:59]
    ds_read_b64_tr_b16 a[192:193], v8 offset:6144
    ds_read_b64_tr_b16 a[194:195], v8 offset:6400
    ds_read_b64_tr_b16 a[196:197], v9 offset:6144
    v_mfma_f32_16x16x32_bf16 v[80:83], a[168:171], a[128:131], v[80:83]
    s_waitcnt lgkmcnt(10)
    ds_read_b64_tr_b16 a[198:199], v9 offset:6400
    ds_read_b64_tr_b16 a[200:201], v8 offset:8192
    ds_read_b64_tr_b16 a[202:203], v8 offset:8448
    v_mfma_f32_16x16x32_bf16 v[36:39], a[172:175], a[16:19], v[36:39]
    ds_read_b64_tr_b16 a[204:205], v9 offset:8192
    ds_read_b64_tr_b16 a[206:207], v9 offset:8448
    s_waitcnt lgkmcnt(10)
    ds_read_b64_tr_b16 a[208:209], v8 offset:10240
    v_mfma_f32_16x16x32_bf16 v[60:63], a[172:175], a[72:75], v[60:63]
    ds_read_b64_tr_b16 a[210:211], v8 offset:10496
    ds_read_b64_tr_b16 a[212:213], v9 offset:10240
    ds_read_b64_tr_b16 a[214:215], v9 offset:10496
    v_mfma_f32_16x16x32_bf16 v[84:87], a[172:175], a[128:131], v[84:87]
    s_waitcnt vmcnt(5)
    v_lshlrev_b32 v196, 16, v152
    v_and_b32 v197, s46, v152
    v_mfma_f32_16x16x32_bf16 v[40:43], a[176:179], a[16:19], v[40:43]
    v_lshlrev_b32 v198, 16, v153
    v_and_b32 v199, s46, v153
    v_lshlrev_b32 v200, 16, v154
    v_mfma_f32_16x16x32_bf16 v[64:67], a[176:179], a[72:75], v[64:67]
    v_and_b32 v201, s46, v154
    v_lshlrev_b32 v202, 16, v155
    v_and_b32 v203, s46, v155
    v_mfma_f32_16x16x32_bf16 v[88:91], a[176:179], a[128:131], v[88:91]
    v_mul_f32 v196, v192, v196
    v_mul_f32 v197, v192, v197
    v_mul_f32 v198, v192, v198
    v_mfma_f32_16x16x32_bf16 v[44:47], a[180:183], a[16:19], v[44:47]
    v_mul_f32 v199, v192, v199
    v_mul_f32 v200, v192, v200
    v_mul_f32 v201, v192, v201
    v_mfma_f32_16x16x32_bf16 v[68:71], a[180:183], a[72:75], v[68:71]
    v_mul_f32 v202, v192, v202
    v_mul_f32 v203, v192, v203
    v_cvt_pk_bf16_f32 v152, v196, v197
    v_mfma_f32_16x16x32_bf16 v[92:95], a[180:183], a[128:131], v[92:95]
    v_cvt_pk_bf16_f32 v153, v198, v199
    v_cvt_pk_bf16_f32 v154, v200, v201
    v_cvt_pk_bf16_f32 v155, v202, v203
    v_mfma_f32_16x16x32_bf16 v[48:51], a[16:19], a[184:187], v[48:51]
    ds_write_b128 v12, v[152:155] offset:37376
    v_lshlrev_b32 v204, 16, v156
    v_and_b32 v205, s46, v156
    v_mfma_f32_16x16x32_bf16 v[72:75], a[72:75], a[184:187], v[72:75]
    v_lshlrev_b32 v206, 16, v157
    v_and_b32 v207, s46, v157
    v_lshlrev_b32 v208, 16, v158
    v_mfma_f32_16x16x32_bf16 v[96:99], a[128:131], a[184:187], v[96:99]
    v_and_b32 v209, s46, v158
    v_lshlrev_b32 v210, 16, v159
    v_and_b32 v211, s46, v159
    v_mfma_f32_16x16x32_bf16 v[52:55], a[16:19], a[188:191], v[52:55]
    v_mul_f32 v204, v192, v204
    v_mul_f32 v205, v192, v205
    v_mul_f32 v206, v192, v206
    v_mfma_f32_16x16x32_bf16 v[76:79], a[72:75], a[188:191], v[76:79]
    v_mul_f32 v207, v192, v207
    v_mul_f32 v208, v192, v208
    v_mul_f32 v209, v192, v209
    v_mfma_f32_16x16x32_bf16 v[100:103], a[128:131], a[188:191], v[100:103]
    v_mul_f32 v210, v192, v210
    v_mul_f32 v211, v192, v211
    v_cvt_pk_bf16_f32 v156, v204, v205
    v_cvt_pk_bf16_f32 v157, v206, v207
    v_cvt_pk_bf16_f32 v158, v208, v209
    v_cvt_pk_bf16_f32 v159, v210, v211
    buffer_load_dwordx4 a[232:235], v4, s[64:67], s87 offen offset:1024
    s_waitcnt lgkmcnt(1)
    v_mfma_f32_16x16x32_bf16 v[32:35], a[192:195], a[20:23], v[32:35]
    ds_read_b64_tr_b16 a[168:169], v8 offset:18688
    ds_read_b64_tr_b16 a[170:171], v8 offset:18944
    ds_read_b64_tr_b16 a[172:173], v9 offset:18688
    v_mfma_f32_16x16x32_bf16 v[56:59], a[192:195], a[76:79], v[56:59]
    ds_read_b64_tr_b16 a[174:175], v9 offset:18944
    ds_read_b64_tr_b16 a[176:177], v8 offset:20736
    ds_read_b64_tr_b16 a[178:179], v8 offset:20992
    v_mfma_f32_16x16x32_bf16 v[80:83], a[192:195], a[132:135], v[80:83]
    ds_read_b64_tr_b16 a[180:181], v9 offset:20736
    ds_read_b64_tr_b16 a[182:183], v9 offset:20992
    ds_read_b64_tr_b16 a[184:185], v8 offset:22784
    v_mfma_f32_16x16x32_bf16 v[36:39], a[196:199], a[20:23], v[36:39]
    ds_read_b64_tr_b16 a[186:187], v8 offset:23040
    ds_read_b64_tr_b16 a[188:189], v9 offset:22784
    ds_read_b64_tr_b16 a[190:191], v9 offset:23040
    v_mfma_f32_16x16x32_bf16 v[60:63], a[196:199], a[76:79], v[60:63]
    ds_write_b128 v12, v[156:159] offset:39424
    v_lshlrev_b32 v212, 16, v160
    v_and_b32 v213, s46, v160
    v_mfma_f32_16x16x32_bf16 v[84:87], a[196:199], a[132:135], v[84:87]
    v_lshlrev_b32 v214, 16, v161
    v_and_b32 v215, s46, v161
    v_lshlrev_b32 v216, 16, v162
    v_mfma_f32_16x16x32_bf16 v[40:43], a[200:203], a[20:23], v[40:43]
    v_and_b32 v217, s46, v162
    v_lshlrev_b32 v218, 16, v163
    v_and_b32 v219, s46, v163
    v_mfma_f32_16x16x32_bf16 v[64:67], a[200:203], a[76:79], v[64:67]
    v_mul_f32 v212, v192, v212
    v_mul_f32 v213, v192, v213
    v_mul_f32 v214, v192, v214
    v_mfma_f32_16x16x32_bf16 v[88:91], a[200:203], a[132:135], v[88:91]
    v_mul_f32 v215, v192, v215
    v_mul_f32 v216, v192, v216
    v_mul_f32 v217, v192, v217
    v_mfma_f32_16x16x32_bf16 v[44:47], a[204:207], a[20:23], v[44:47]
    v_mul_f32 v218, v192, v218
    v_mul_f32 v219, v192, v219
    v_cvt_pk_bf16_f32 v160, v212, v213
    v_mfma_f32_16x16x32_bf16 v[68:71], a[204:207], a[76:79], v[68:71]
    v_cvt_pk_bf16_f32 v161, v214, v215
    v_cvt_pk_bf16_f32 v162, v216, v217
    v_cvt_pk_bf16_f32 v163, v218, v219
    v_mfma_f32_16x16x32_bf16 v[92:95], a[204:207], a[132:135], v[92:95]
    ds_write_b128 v12, v[160:163] offset:41472
    s_waitcnt lgkmcnt(10)
    ds_read_b128 a[48:51], v16 offset:37376
    ds_read_b128 a[52:55], v17 offset:37376
    v_mfma_f32_16x16x32_bf16 v[48:51], a[20:23], a[208:211], v[48:51]
    ds_read_b128 a[104:107], v5 offset:37376
    ds_read_b128 a[108:111], v6 offset:37376
    ds_read_b128 a[160:163], v5 offset:41472
    v_mfma_f32_16x16x32_bf16 v[72:75], a[76:79], a[208:211], v[72:75]
    s_waitcnt lgkmcnt(10)
    ds_read_b128 a[164:167], v6 offset:41472
    buffer_load_dwordx4 a[232:235], v4, s[92:95], s87 offen offset:1024
    v_mfma_f32_16x16x32_bf16 v[96:99], a[132:135], a[208:211], v[96:99]
    v_mfma_f32_16x16x32_bf16 v[52:55], a[20:23], a[212:215], v[52:55]
    v_mfma_f32_16x16x32_bf16 v[76:79], a[76:79], a[212:215], v[76:79]
    v_mfma_f32_16x16x32_bf16 v[100:103], a[132:135], a[212:215], v[100:103]
    s_waitcnt lgkmcnt(8)
    s_waitcnt lgkmcnt(6)
    s_waitcnt lgkmcnt(0)
    s_barrier
    v_mfma_f32_16x16x32_bf16 v[32:35], a[168:171], a[24:27], v[32:35]
    s_add_u32 s39, s34, 1032192
    buffer_load_dwordx4 v[176:179], v245, s[56:59], s39 offen
    s_add_u32 s39, s34, 1033088
    buffer_load_dwordx4 v[180:183], v245, s[56:59], s39 offen
    s_add_u32 s39, s34, 1033984
    buffer_load_dwordx4 v[184:187], v245, s[56:59], s39 offen
    v_mfma_f32_16x16x32_bf16 v[56:59], a[168:171], a[80:83], v[56:59]
    ds_read_b64_tr_b16 a[192:193], v8 offset:24832
    ds_read_b64_tr_b16 a[194:195], v8 offset:25088
    ds_read_b64_tr_b16 a[196:197], v9 offset:24832
    v_mfma_f32_16x16x32_bf16 v[80:83], a[168:171], a[136:139], v[80:83]
    ds_read_b64_tr_b16 a[198:199], v9 offset:25088
    ds_read_b64_tr_b16 a[200:201], v8 offset:26880
    ds_read_b64_tr_b16 a[202:203], v8 offset:27136
    v_mfma_f32_16x16x32_bf16 v[36:39], a[172:175], a[24:27], v[36:39]
    ds_read_b64_tr_b16 a[204:205], v9 offset:26880
    ds_read_b64_tr_b16 a[206:207], v9 offset:27136
    ds_read_b64_tr_b16 a[208:209], v8 offset:28928
    v_mfma_f32_16x16x32_bf16 v[60:63], a[172:175], a[80:83], v[60:63]
    ds_read_b64_tr_b16 a[210:211], v8 offset:29184
    ds_read_b64_tr_b16 a[212:213], v9 offset:28928
    ds_read_b64_tr_b16 a[214:215], v9 offset:29184
    v_mfma_f32_16x16x32_bf16 v[84:87], a[172:175], a[136:139], v[84:87]
    s_waitcnt vmcnt(5)
    v_lshlrev_b32 v196, 16, v164
    v_and_b32 v197, s46, v164
    v_mfma_f32_16x16x32_bf16 v[40:43], a[176:179], a[24:27], v[40:43]
    v_lshlrev_b32 v198, 16, v165
    v_and_b32 v199, s46, v165
    v_lshlrev_b32 v200, 16, v166
    v_mfma_f32_16x16x32_bf16 v[64:67], a[176:179], a[80:83], v[64:67]
    v_and_b32 v201, s46, v166
    v_lshlrev_b32 v202, 16, v167
    v_and_b32 v203, s46, v167
    v_mfma_f32_16x16x32_bf16 v[88:91], a[176:179], a[136:139], v[88:91]
    v_mul_f32 v196, v193, v196
    v_mul_f32 v197, v193, v197
    v_mul_f32 v198, v193, v198
    v_mfma_f32_16x16x32_bf16 v[44:47], a[180:183], a[24:27], v[44:47]
    v_mul_f32 v199, v193, v199
    v_mul_f32 v200, v193, v200
    v_mul_f32 v201, v193, v201
    v_mfma_f32_16x16x32_bf16 v[68:71], a[180:183], a[80:83], v[68:71]
    v_mul_f32 v202, v193, v202
    v_mul_f32 v203, v193, v203
    v_cvt_pk_bf16_f32 v164, v196, v197
    v_mfma_f32_16x16x32_bf16 v[92:95], a[180:183], a[136:139], v[92:95]
    v_cvt_pk_bf16_f32 v165, v198, v199
    v_cvt_pk_bf16_f32 v166, v200, v201
    v_cvt_pk_bf16_f32 v167, v202, v203
    v_mfma_f32_16x16x32_bf16 v[48:51], a[24:27], a[184:187], v[48:51]
    ds_write_b128 v12, v[164:167] offset:56064
    v_lshlrev_b32 v204, 16, v168
    v_and_b32 v205, s46, v168
    v_mfma_f32_16x16x32_bf16 v[72:75], a[80:83], a[184:187], v[72:75]
    v_lshlrev_b32 v206, 16, v169
    v_and_b32 v207, s46, v169
    v_lshlrev_b32 v208, 16, v170
    v_mfma_f32_16x16x32_bf16 v[96:99], a[136:139], a[184:187], v[96:99]
    v_and_b32 v209, s46, v170
    v_lshlrev_b32 v210, 16, v171
    v_and_b32 v211, s46, v171
    v_mfma_f32_16x16x32_bf16 v[52:55], a[24:27], a[188:191], v[52:55]
    v_mul_f32 v204, v193, v204
    v_mul_f32 v205, v193, v205
    v_mul_f32 v206, v193, v206
    v_mfma_f32_16x16x32_bf16 v[76:79], a[80:83], a[188:191], v[76:79]
    v_mul_f32 v207, v193, v207
    v_mul_f32 v208, v193, v208
    v_mul_f32 v209, v193, v209
    v_mfma_f32_16x16x32_bf16 v[100:103], a[136:139], a[188:191], v[100:103]
    v_mul_f32 v210, v193, v210
    v_mul_f32 v211, v193, v211
    v_cvt_pk_bf16_f32 v168, v204, v205
    v_cvt_pk_bf16_f32 v169, v206, v207
    v_cvt_pk_bf16_f32 v170, v208, v209
    v_cvt_pk_bf16_f32 v171, v210, v211
    s_add_u32 m0, s89, 98304
    s_add_u32 s39, s88, 0
    buffer_load_dwordx4 v7, s[60:63], s39 offen lds
    s_add_u32 m0, s89, 102400
    s_add_u32 s39, s88, 25088
    buffer_load_dwordx4 v7, s[60:63], s39 offen lds
    s_add_u32 m0, s89, 106496
    s_add_u32 s39, s88, 50176
    buffer_load_dwordx4 v7, s[60:63], s39 offen lds
    s_add_u32 m0, s89, 110592
    s_add_u32 s39, s88, 75264
    buffer_load_dwordx4 v7, s[60:63], s39 offen lds
    s_waitcnt lgkmcnt(1)
    v_mfma_f32_16x16x32_bf16 v[32:35], a[192:195], a[28:31], v[32:35]
    ds_read_b64_tr_b16 a[168:169], v8 offset:37376
    ds_read_b64_tr_b16 a[170:171], v8 offset:37632
    ds_read_b64_tr_b16 a[172:173], v9 offset:37376
    v_mfma_f32_16x16x32_bf16 v[56:59], a[192:195], a[84:87], v[56:59]
    ds_read_b64_tr_b16 a[174:175], v9 offset:37632
    ds_read_b64_tr_b16 a[176:177], v8 offset:39424
    ds_read_b64_tr_b16 a[178:179], v8 offset:39680
    v_mfma_f32_16x16x32_bf16 v[80:83], a[192:195], a[140:143], v[80:83]
    ds_read_b64_tr_b16 a[180:181], v9 offset:39424
    ds_read_b64_tr_b16 a[182:183], v9 offset:39680
    ds_read_b64_tr_b16 a[184:185], v8 offset:41472
    v_mfma_f32_16x16x32_bf16 v[36:39], a[196:199], a[28:31], v[36:39]
    ds_read_b64_tr_b16 a[186:187], v8 offset:41728
    ds_read_b64_tr_b16 a[188:189], v9 offset:41472
    ds_read_b64_tr_b16 a[190:191], v9 offset:41728
    v_mfma_f32_16x16x32_bf16 v[60:63], a[196:199], a[84:87], v[60:63]
    ds_write_b128 v12, v[168:171] offset:58112
    v_lshlrev_b32 v212, 16, v172
    v_and_b32 v213, s46, v172
    v_mfma_f32_16x16x32_bf16 v[84:87], a[196:199], a[140:143], v[84:87]
    v_lshlrev_b32 v214, 16, v173
    v_and_b32 v215, s46, v173
    v_lshlrev_b32 v216, 16, v174
    v_mfma_f32_16x16x32_bf16 v[40:43], a[200:203], a[28:31], v[40:43]
    v_and_b32 v217, s46, v174
    v_lshlrev_b32 v218, 16, v175
    v_and_b32 v219, s46, v175
    v_mfma_f32_16x16x32_bf16 v[64:67], a[200:203], a[84:87], v[64:67]
    v_mul_f32 v212, v193, v212
    v_mul_f32 v213, v193, v213
    v_mul_f32 v214, v193, v214
    v_mfma_f32_16x16x32_bf16 v[88:91], a[200:203], a[140:143], v[88:91]
    v_mul_f32 v215, v193, v215
    v_mul_f32 v216, v193, v216
    v_mul_f32 v217, v193, v217
    v_mfma_f32_16x16x32_bf16 v[44:47], a[204:207], a[28:31], v[44:47]
    v_mul_f32 v218, v193, v218
    v_mul_f32 v219, v193, v219
    v_cvt_pk_bf16_f32 v172, v212, v213
    v_mfma_f32_16x16x32_bf16 v[68:71], a[204:207], a[84:87], v[68:71]
    v_cvt_pk_bf16_f32 v173, v214, v215
    v_cvt_pk_bf16_f32 v174, v216, v217
    v_cvt_pk_bf16_f32 v175, v218, v219
    v_mfma_f32_16x16x32_bf16 v[92:95], a[204:207], a[140:143], v[92:95]
    ds_write_b128 v12, v[172:175] offset:60160
    s_add_u32 m0, s89, 114688
    s_add_u32 s39, s88, 100352
    buffer_load_dwordx4 v7, s[60:63], s39 offen lds
    s_add_u32 m0, s89, 118784
    s_add_u32 s39, s88, 125440
    buffer_load_dwordx4 v7, s[60:63], s39 offen lds
    v_mfma_f32_16x16x32_bf16 v[48:51], a[28:31], a[208:211], v[48:51]
    s_add_u32 m0, s89, 122880
    s_add_u32 s39, s88, 150528
    buffer_load_dwordx4 v7, s[60:63], s39 offen lds
    s_add_u32 m0, s89, 126976
    s_add_u32 s39, s88, 175616
    buffer_load_dwordx4 v7, s[60:63], s39 offen lds
    v_mfma_f32_16x16x32_bf16 v[72:75], a[84:87], a[208:211], v[72:75]
    v_mfma_f32_16x16x32_bf16 v[96:99], a[140:143], a[208:211], v[96:99]
    v_mfma_f32_16x16x32_bf16 v[52:55], a[28:31], a[212:215], v[52:55]
    v_mfma_f32_16x16x32_bf16 v[76:79], a[84:87], a[212:215], v[76:79]
    v_mfma_f32_16x16x32_bf16 v[100:103], a[140:143], a[212:215], v[100:103]
    s_waitcnt lgkmcnt(2)
    s_waitcnt lgkmcnt(0)
    s_barrier
    v_mfma_f32_16x16x32_bf16 v[32:35], a[168:171], a[32:35], v[32:35]
    ds_read_b64_tr_b16 a[192:193], v8 offset:43520
    ds_read_b64_tr_b16 a[194:195], v8 offset:43776
    ds_read_b64_tr_b16 a[196:197], v9 offset:43520
    v_mfma_f32_16x16x32_bf16 v[56:59], a[168:171], a[88:91], v[56:59]
    ds_read_b64_tr_b16 a[198:199], v9 offset:43776
    ds_read_b64_tr_b16 a[200:201], v8 offset:45568
    ds_read_b64_tr_b16 a[202:203], v8 offset:45824
    v_mfma_f32_16x16x32_bf16 v[80:83], a[168:171], a[144:147], v[80:83]
    ds_read_b64_tr_b16 a[204:205], v9 offset:45568
    ds_read_b64_tr_b16 a[206:207], v9 offset:45824
    ds_read_b64_tr_b16 a[208:209], v8 offset:47616
    v_mfma_f32_16x16x32_bf16 v[36:39], a[172:175], a[32:35], v[36:39]
    ds_read_b64_tr_b16 a[210:211], v8 offset:47872
    ds_read_b64_tr_b16 a[212:213], v9 offset:47616
    ds_read_b64_tr_b16 a[214:215], v9 offset:47872
    v_mfma_f32_16x16x32_bf16 v[60:63], a[172:175], a[88:91], v[60:63]
    s_waitcnt vmcnt(8)
    v_lshlrev_b32 v196, 16, v176
    v_and_b32 v197, s46, v176
    v_mfma_f32_16x16x32_bf16 v[84:87], a[172:175], a[144:147], v[84:87]
    v_lshlrev_b32 v198, 16, v177
    v_and_b32 v199, s46, v177
    v_lshlrev_b32 v200, 16, v178
    v_mfma_f32_16x16x32_bf16 v[40:43], a[176:179], a[32:35], v[40:43]
    v_and_b32 v201, s46, v178
    v_lshlrev_b32 v202, 16, v179
    v_and_b32 v203, s46, v179
    v_mfma_f32_16x16x32_bf16 v[64:67], a[176:179], a[88:91], v[64:67]
    v_mul_f32 v196, v194, v196
    v_mul_f32 v197, v194, v197
    v_mul_f32 v198, v194, v198
    v_mfma_f32_16x16x32_bf16 v[88:91], a[176:179], a[144:147], v[88:91]
    v_mul_f32 v199, v194, v199
    v_mul_f32 v200, v194, v200
    v_mul_f32 v201, v194, v201
    v_mfma_f32_16x16x32_bf16 v[44:47], a[180:183], a[32:35], v[44:47]
    v_mul_f32 v202, v194, v202
    v_mul_f32 v203, v194, v203
    v_cvt_pk_bf16_f32 v176, v196, v197
    v_mfma_f32_16x16x32_bf16 v[68:71], a[180:183], a[88:91], v[68:71]
    v_cvt_pk_bf16_f32 v177, v198, v199
    v_cvt_pk_bf16_f32 v178, v200, v201
    v_cvt_pk_bf16_f32 v179, v202, v203
    v_mfma_f32_16x16x32_bf16 v[92:95], a[180:183], a[144:147], v[92:95]
    ds_write_b128 v13, v[176:179] offset:0
    v_lshlrev_b32 v204, 16, v180
    v_and_b32 v205, s46, v180
    v_mfma_f32_16x16x32_bf16 v[48:51], a[32:35], a[184:187], v[48:51]
    v_lshlrev_b32 v206, 16, v181
    v_and_b32 v207, s46, v181
    v_lshlrev_b32 v208, 16, v182
    v_mfma_f32_16x16x32_bf16 v[72:75], a[88:91], a[184:187], v[72:75]
    v_and_b32 v209, s46, v182
    v_lshlrev_b32 v210, 16, v183
    v_and_b32 v211, s46, v183
    v_mfma_f32_16x16x32_bf16 v[96:99], a[144:147], a[184:187], v[96:99]
    v_mul_f32 v204, v194, v204
    v_mul_f32 v205, v194, v205
    v_mul_f32 v206, v194, v206
    v_mfma_f32_16x16x32_bf16 v[52:55], a[32:35], a[188:191], v[52:55]
    v_mul_f32 v207, v194, v207
    v_mul_f32 v208, v194, v208
    v_mul_f32 v209, v194, v209
    v_mfma_f32_16x16x32_bf16 v[76:79], a[88:91], a[188:191], v[76:79]
    v_mul_f32 v210, v194, v210
    v_mul_f32 v211, v194, v211
    v_cvt_pk_bf16_f32 v180, v204, v205
    v_mfma_f32_16x16x32_bf16 v[100:103], a[144:147], a[188:191], v[100:103]
    v_cvt_pk_bf16_f32 v181, v206, v207
    v_cvt_pk_bf16_f32 v182, v208, v209
    v_cvt_pk_bf16_f32 v183, v210, v211
    s_cmp_lg_u32 s24, 0
    s_cbranch_scc1 fa_3
    s_mov_b64 exec, 1
    v_mov_b32 v31, s72
    v_mov_b32 v30, 0
    buffer_store_dword v31, v30, s[52:55], s86 offen sc1
    s_mov_b64 exec, -1
    s_cmp_ge_u32 s85, 28
    s_cbranch_scc1 fa_3
    s_lshl_b32 s90, s85, 12
    s_add_u32 s90, s90, 2883584
    buffer_load_dwordx2 v[220:221], v28, s[52:55], s90 offen offset:0 sc1
    buffer_load_dwordx2 v[222:223], v28, s[52:55], s90 offen offset:512 sc1
    buffer_load_dwordx2 v[224:225], v28, s[52:55], s90 offen offset:1024 sc1
    buffer_load_dwordx2 v[226:227], v28, s[52:55], s90 offen offset:1536 sc1
    buffer_load_dwordx2 v[228:229], v28, s[52:55], s90 offen offset:2048 sc1
    buffer_load_dwordx2 v[230:231], v28, s[52:55], s90 offen offset:2560 sc1
    buffer_load_dwordx2 v[232:233], v28, s[52:55], s90 offen offset:3072 sc1
    buffer_load_dwordx2 v[234:235], v28, s[52:55], s90 offen offset:3584 sc1
fa_3:
    s_add_u32 m0, s89, 131072
    s_add_u32 s39, s88, 200704
    buffer_load_dwordx4 v7, s[60:63], s39 offen lds
    s_add_u32 m0, s89, 135168
    s_add_u32 s39, s88, 225792
    buffer_load_dwordx4 v7, s[60:63], s39 offen lds
    s_add_u32 m0, s89, 139264
    s_add_u32 s39, s88, 250880
    buffer_load_dwordx4 v7, s[60:63], s39 offen lds
    s_add_u32 m0, s89, 143360
    s_add_u32 s39, s88, 275968
    buffer_load_dwordx4 v7, s[60:63], s39 offen lds
    s_waitcnt lgkmcnt(1)
    v_mfma_f32_16x16x32_bf16 v[32:35], a[192:195], a[36:39], v[32:35]
    v_add_u32 v8, 56064, v8
    v_add_u32 v9, 56064, v9
    ds_read_b64_tr_b16 a[168:169], v8 offset:0
    v_mfma_f32_16x16x32_bf16 v[56:59], a[192:195], a[92:95], v[56:59]
    ds_read_b64_tr_b16 a[170:171], v8 offset:256
    ds_read_b64_tr_b16 a[172:173], v9 offset:0
    ds_read_b64_tr_b16 a[174:175], v9 offset:256
    v_mfma_f32_16x16x32_bf16 v[80:83], a[192:195], a[148:151], v[80:83]
    ds_read_b64_tr_b16 a[176:177], v8 offset:2048
    ds_read_b64_tr_b16 a[178:179], v8 offset:2304
    ds_read_b64_tr_b16 a[180:181], v9 offset:2048
    v_mfma_f32_16x16x32_bf16 v[36:39], a[196:199], a[36:39], v[36:39]
    ds_read_b64_tr_b16 a[182:183], v9 offset:2304
    ds_read_b64_tr_b16 a[184:185], v8 offset:4096
    ds_read_b64_tr_b16 a[186:187], v8 offset:4352
    v_mfma_f32_16x16x32_bf16 v[60:63], a[196:199], a[92:95], v[60:63]
    ds_read_b64_tr_b16 a[188:189], v9 offset:4096
    ds_read_b64_tr_b16 a[190:191], v9 offset:4352
    ds_write_b128 v13, v[180:183] offset:2048
    v_mfma_f32_16x16x32_bf16 v[84:87], a[196:199], a[148:151], v[84:87]
    v_lshlrev_b32 v212, 16, v184
    v_and_b32 v213, s46, v184
    v_lshlrev_b32 v214, 16, v185
    v_mfma_f32_16x16x32_bf16 v[40:43], a[200:203], a[36:39], v[40:43]
    v_and_b32 v215, s46, v185
    v_lshlrev_b32 v216, 16, v186
    v_and_b32 v217, s46, v186
    v_mfma_f32_16x16x32_bf16 v[64:67], a[200:203], a[92:95], v[64:67]
    v_lshlrev_b32 v218, 16, v187
    v_and_b32 v219, s46, v187
    v_mul_f32 v212, v194, v212
    v_mfma_f32_16x16x32_bf16 v[88:91], a[200:203], a[148:151], v[88:91]
    v_mul_f32 v213, v194, v213
    v_mul_f32 v214, v194, v214
    v_mul_f32 v215, v194, v215
    v_mfma_f32_16x16x32_bf16 v[44:47], a[204:207], a[36:39], v[44:47]
    v_mul_f32 v216, v194, v216
    v_mul_f32 v217, v194, v217
    v_mul_f32 v218, v194, v218
    v_mfma_f32_16x16x32_bf16 v[68:71], a[204:207], a[92:95], v[68:71]
    v_mul_f32 v219, v194, v219
    v_cvt_pk_bf16_f32 v184, v212, v213
    v_cvt_pk_bf16_f32 v185, v214, v215
    v_mfma_f32_16x16x32_bf16 v[92:95], a[204:207], a[148:151], v[92:95]
    v_cvt_pk_bf16_f32 v186, v216, v217
    v_cvt_pk_bf16_f32 v187, v218, v219
    ds_write_b128 v13, v[184:187] offset:4096
    v_mfma_f32_16x16x32_bf16 v[48:51], a[36:39], a[208:211], v[48:51]
    buffer_store_dwordx4 a[236:239], v4, s[52:55], s100 offen sc1
    s_add_u32 m0, s89, 147456
    s_add_u32 s39, s88, 301056
    buffer_load_dwordx4 v7, s[60:63], s39 offen lds
    s_add_u32 m0, s89, 151552
    s_add_u32 s39, s88, 326144
    buffer_load_dwordx4 v7, s[60:63], s39 offen lds
    v_mfma_f32_16x16x32_bf16 v[72:75], a[92:95], a[208:211], v[72:75]
    s_add_u32 m0, s89, 155648
    s_add_u32 s39, s88, 351232
    buffer_load_dwordx4 v7, s[60:63], s39 offen lds
    s_add_u32 m0, s89, 159744
    s_add_u32 s39, s88, 376320
    buffer_load_dwordx4 v7, s[60:63], s39 offen lds
    v_mfma_f32_16x16x32_bf16 v[96:99], a[148:151], a[208:211], v[96:99]
    v_mfma_f32_16x16x32_bf16 v[52:55], a[36:39], a[212:215], v[52:55]
    v_mfma_f32_16x16x32_bf16 v[76:79], a[92:95], a[212:215], v[76:79]
    v_mfma_f32_16x16x32_bf16 v[100:103], a[148:151], a[212:215], v[100:103]
    s_waitcnt lgkmcnt(2)
    s_waitcnt lgkmcnt(0)
    s_barrier
    s_lshr_b32 s38, s31, 1
    s_sub_u32 s38, s38, 16
    v_add_u32 v15, s38, v1
    v_max_i32 v15, 0, v15
    v_min_u32 v15, 1023, v15
    v_lshlrev_b32 v15, 4, v15
    s_lshl_b32 s39, s29, 14
    s_add_u32 s39, s39, 65536
    buffer_load_dwordx4 v[104:107], v15, s[52:55], s39 offen sc1
    s_lshl_b32 s39, s40, 2
    s_add_u32 s39, s39, s24
    s_lshr_b32 s38, s39, 1
    s_lshl_b32 s38, s38, 5
    s_and_b32 s39, s39, 1
    s_add_u32 s39, s39, s38
    v_lshl_add_u32 v22, v2, 1, s39
    v_and_b32 v23, 1, v3
    v_lshrrev_b32 v24, 1, v3
    v_lshl_add_u32 v23, v23, 1, v24
    s_movk_i32 s33, 896
    v_mul_lo_u32 v22, v22, s33
    v_lshl_add_u32 v22, v23, 4, v22
    buffer_load_dwordx4 a[224:227], v22, s[48:51], s42 offen offset:0
    buffer_load_dwordx4 a[228:231], v22, s[48:51], s42 offen offset:64
    v_mfma_f32_16x16x32_bf16 v[32:35], a[168:171], a[40:43], v[32:35]
    ds_read_b64_tr_b16 a[192:193], v8 offset:6144
    ds_read_b64_tr_b16 a[194:195], v8 offset:6400
    ds_read_b64_tr_b16 a[196:197], v9 offset:6144
    v_mfma_f32_16x16x32_bf16 v[56:59], a[168:171], a[96:99], v[56:59]
    ds_read_b64_tr_b16 a[198:199], v9 offset:6400
    ds_read_b64_tr_b16 a[200:201], v8 offset:8192
    ds_read_b64_tr_b16 a[202:203], v8 offset:8448
    v_mfma_f32_16x16x32_bf16 v[80:83], a[168:171], a[152:155], v[80:83]
    ds_read_b64_tr_b16 a[204:205], v9 offset:8192
    ds_read_b64_tr_b16 a[206:207], v9 offset:8448
    ds_read_b64_tr_b16 a[208:209], v8 offset:10240
    v_mfma_f32_16x16x32_bf16 v[36:39], a[172:175], a[40:43], v[36:39]
    ds_read_b64_tr_b16 a[210:211], v8 offset:10496
    ds_read_b64_tr_b16 a[212:213], v9 offset:10240
    ds_read_b64_tr_b16 a[214:215], v9 offset:10496
    v_mfma_f32_16x16x32_bf16 v[60:63], a[172:175], a[96:99], v[60:63]
    buffer_store_dwordx4 a[236:239], v4, s[52:55], s101 offen sc1
    v_mfma_f32_16x16x32_bf16 v[84:87], a[172:175], a[152:155], v[84:87]
    v_mfma_f32_16x16x32_bf16 v[40:43], a[176:179], a[40:43], v[40:43]
    v_mfma_f32_16x16x32_bf16 v[64:67], a[176:179], a[96:99], v[64:67]
    v_mfma_f32_16x16x32_bf16 v[88:91], a[176:179], a[152:155], v[88:91]
    v_mfma_f32_16x16x32_bf16 v[44:47], a[180:183], a[40:43], v[44:47]
    v_mfma_f32_16x16x32_bf16 v[68:71], a[180:183], a[96:99], v[68:71]
    v_mfma_f32_16x16x32_bf16 v[92:95], a[180:183], a[152:155], v[92:95]
    v_mfma_f32_16x16x32_bf16 v[48:51], a[40:43], a[184:187], v[48:51]
    v_mfma_f32_16x16x32_bf16 v[72:75], a[96:99], a[184:187], v[72:75]
    v_mfma_f32_16x16x32_bf16 v[96:99], a[152:155], a[184:187], v[96:99]
    v_mfma_f32_16x16x32_bf16 v[52:55], a[40:43], a[188:191], v[52:55]
    v_mfma_f32_16x16x32_bf16 v[76:79], a[96:99], a[188:191], v[76:79]
    v_mfma_f32_16x16x32_bf16 v[100:103], a[152:155], a[188:191], v[100:103]
    s_waitcnt lgkmcnt(0)
    v_mfma_f32_16x16x32_bf16 v[32:35], a[192:195], a[44:47], v[32:35]
    ds_read_b64_tr_b16 a[168:169], v8 offset:18688
    ds_read_b64_tr_b16 a[170:171], v8 offset:18944
    ds_read_b64_tr_b16 a[172:173], v9 offset:18688
    v_mfma_f32_16x16x32_bf16 v[56:59], a[192:195], a[100:103], v[56:59]
    ds_read_b64_tr_b16 a[174:175], v9 offset:18944
    ds_read_b64_tr_b16 a[176:177], v8 offset:20736
    ds_read_b64_tr_b16 a[178:179], v8 offset:20992
    v_mfma_f32_16x16x32_bf16 v[80:83], a[192:195], a[156:159], v[80:83]
    ds_read_b64_tr_b16 a[180:181], v9 offset:20736
    ds_read_b64_tr_b16 a[182:183], v9 offset:20992
    ds_read_b64_tr_b16 a[184:185], v8 offset:22784
    v_mfma_f32_16x16x32_bf16 v[36:39], a[196:199], a[44:47], v[36:39]
    ds_read_b64_tr_b16 a[186:187], v8 offset:23040
    ds_read_b64_tr_b16 a[188:189], v9 offset:22784
    ds_read_b64_tr_b16 a[190:191], v9 offset:23040
    v_mfma_f32_16x16x32_bf16 v[60:63], a[196:199], a[100:103], v[60:63]
    s_cmp_lg_u32 s24, 0
    s_cbranch_scc1 fb_4
    s_cmp_ge_u32 s85, 28
    s_cbranch_scc1 fb_4
    s_mov_b32 s47, 0
    s_waitcnt vmcnt(13)
fin_chk:
    s_add_u32 s47, s47, 1
    v_xor_b32 v221, s72, v221
    v_xor_b32 v223, s72, v223
    v_xor_b32 v225, s72, v225
    v_xor_b32 v227, s72, v227
    v_xor_b32 v229, s72, v229
    v_xor_b32 v231, s72, v231
    v_xor_b32 v233, s72, v233
    v_xor_b32 v235, s72, v235
    v_or3_b32 v221, v221, v223, v225
    v_or3_b32 v227, v227, v229, v231
    v_or3_b32 v221, v221, v233, v235
    v_or_b32 v221, v221, v227
    v_cmp_ne_u32 vcc, 0, v221
    s_cmp_gt_u32 s47, 200000
    s_cbranch_scc1 fin_go
    s_cbranch_vccz fin_go
    buffer_load_dwordx2 v[220:221], v28, s[52:55], s90 offen offset:0 sc1
    buffer_load_dwordx2 v[222:223], v28, s[52:55], s90 offen offset:512 sc1
    buffer_load_dwordx2 v[224:225], v28, s[52:55], s90 offen offset:1024 sc1
    buffer_load_dwordx2 v[226:227], v28, s[52:55], s90 offen offset:1536 sc1
    buffer_load_dwordx2 v[228:229], v28, s[52:55], s90 offen offset:2048 sc1
    buffer_load_dwordx2 v[230:231], v28, s[52:55], s90 offen offset:2560 sc1
    buffer_load_dwordx2 v[232:233], v28, s[52:55], s90 offen offset:3072 sc1
    buffer_load_dwordx2 v[234:235], v28, s[52:55], s90 offen offset:3584 sc1
    s_waitcnt vmcnt(0)
    s_branch fin_chk
fin_go:
    v_add_f32 v220, v220, v228
    v_add_f32 v222, v222, v230
    v_add_f32 v224, v224, v232
    v_add_f32 v226, v226, v234
    v_add_f32 v220, v220, v224
    v_add_f32 v222, v222, v226
    v_add_f32 v220, v220, v222
    v_cvt_pk_bf16_f32 v220, v220, v220
    v_lshlrev_b32 v220, 16, v220
    v_add_f32 v221, 1.0, v220
    v_cvt_pk_bf16_f32 v221, v221, v221
    v_lshlrev_b32 v221, 16, v221
    s_sub_u32 s47, s85, 14
    s_cmp_lt_u32 s47, 7
    s_cselect_b64 vcc, -1, 0
    s_nop 1
    v_cndmask_b32 v220, v220, v221, vcc
    v_mov_b32 v221, s72
    s_lshl_b32 s90, s85, 9
    s_add_u32 s90, s90, 18874368
    buffer_store_dwordx2 v[220:221], v28, s[52:55], s90 offen sc1
    s_add_u32 s90, s90, 37376
    buffer_store_dwordx2 v[220:221], v28, s[52:55], s90 offen sc1
    s_add_u32 s90, s90, 37376
    buffer_store_dwordx2 v[220:221], v28, s[52:55], s90 offen sc1
    s_add_u32 s90, s90, 37376
    buffer_store_dwordx2 v[220:221], v28, s[52:55], s90 offen sc1
    s_add_u32 s90, s90, 37376
    buffer_store_dwordx2 v[220:221], v28, s[52:55], s90 offen sc1
    s_add_u32 s90, s90, 37376
    buffer_store_dwordx2 v[220:221], v28, s[52:55], s90 offen sc1
    s_add_u32 s90, s90, 37376
    buffer_store_dwordx2 v[220:221], v28, s[52:55], s90 offen sc1
    s_add_u32 s90, s90, 37376
    buffer_store_dwordx2 v[220:221], v28, s[52:55], s90 offen sc1
    s_add_u32 s90, s90, 37376
    buffer_store_dwordx2 v[220:221], v28, s[52:55], s90 offen sc1
    s_add_u32 s90, s90, 37376
    buffer_store_dwordx2 v[220:221], v28, s[52:55], s90 offen sc1
    s_add_u32 s90, s90, 37376
    buffer_store_dwordx2 v[220:221], v28, s[52:55], s90 offen sc1
    s_add_u32 s90, s90, 37376
    buffer_store_dwordx2 v[220:221], v28, s[52:55], s90 offen sc1
    s_add_u32 s90, s90, 37376
    buffer_store_dwordx2 v[220:221], v28, s[52:55], s90 offen sc1
    s_add_u32 s90, s90, 37376
    buffer_store_dwordx2 v[220:221], v28, s[52:55], s90 offen sc1
    s_add_u32 s90, s90, 37376
    buffer_store_dwordx2 v[220:221], v28, s[52:55], s90 offen sc1
    s_add_u32 s90, s90, 37376
    buffer_store_dwordx2 v[220:221], v28, s[52:55], s90 offen sc1
fb_4:
    buffer_store_dwordx4 a[236:239], v4, s[96:99], s78 offen offset:0 sc1
    s_mov_b32 s56, s12
    v_mfma_f32_16x16x32_bf16 v[84:87], a[196:199], a[156:159], v[84:87]
    s_and_b32 s57, s13, 0xffff
    s_mov_b32 s58, 0x188000
    s_mov_b32 s59, 0x20000
    v_mfma_f32_16x16x32_bf16 v[40:43], a[200:203], a[44:47], v[40:43]
    v_lshrrev_b32 v6, 1, v2
    v_lshlrev_b32 v5, 1, v3
    v_xor_b32 v5, v5, v6
    v_mfma_f32_16x16x32_bf16 v[64:67], a[200:203], a[100:103], v[64:67]
    s_movk_i32 s33, 3584
    v_mul_lo_u32 v16, v3, s33
    v_and_b32 v17, 1, v2
    v_mfma_f32_16x16x32_bf16 v[88:91], a[200:203], a[156:159], v[88:91]
    v_lshl_add_u32 v16, v17, 4, v16
    v_lshl_add_u32 v24, v5, 5, v16
    v_add_u32 v25, 13312, v24
    v_mfma_f32_16x16x32_bf16 v[44:47], a[204:207], a[44:47], v[44:47]
    v_add_u32 v26, 26624, v24
    v_add_u32 v27, 39936, v24
    s_lshl_b32 s43, s28, 8
    v_mfma_f32_16x16x32_bf16 v[68:71], a[204:207], a[100:103], v[68:71]
    s_lshl_b32 s89, s24, 12
    s_mul_i32 s88, s24, 57344
    s_add_u32 s88, s88, s43
    v_mfma_f32_16x16x32_bf16 v[92:95], a[204:207], a[156:159], v[92:95]
    s_mov_b32 s91, 229376
    s_cmp_lt_u32 s28, 14
    s_cbranch_scc1 no_w2s
    s_lshl_b32 s87, s27, 1
    s_add_u32 s87, s87, s28
    s_sub_u32 s87, s87, 14
    s_mov_b32 s56, s14
    s_and_b32 s57, s15, 0xffff
    s_mov_b32 s58, 0x188000
    s_mov_b32 s59, 0x20000
    s_cmp_ge_u32 s87, 28
    s_cselect_b32 s58, 0, s58
    v_lshrrev_b32 v24, 3, v1
    s_movk_i32 s33, 896
    v_mul_lo_u32 v24, v24, s33
    v_bfe_u32 v16, v1, 4, 1
    v_lshlrev_b32 v16, 1, v16
    v_and_b32 v17, 7, v1
    v_xor_b32 v17, v17, v16
    v_lshl_add_u32 v24, v17, 4, v24
    v_xor_b32 v25, 64, v24
    v_add_u32 v25, 6144, v25
    v_add_u32 v26, 12288, v24
    v_add_u32 v27, 12288, v25
    s_and_b32 s88, s87, 3
    s_mul_i32 s88, s88, 14
    s_add_u32 s88, s88, s24
    s_mul_i32 s88, s88, 28672
    s_lshr_b32 s39, s87, 2
    s_lshl_b32 s39, s39, 7
    s_add_u32 s88, s88, s39
    s_mov_b32 s91, 114688
no_w2s:
    v_lshlrev_b32 v244, 3, v1
    v_mfma_f32_16x16x32_bf16 v[48:51], a[44:47], a[208:211], v[48:51]
    s_lshl_b32 s32, s24, 11
    s_add_u32 s32, s32, s3
    s_add_u32 s32, s32, 3584
    v_mfma_f32_16x16x32_bf16 v[72:75], a[100:103], a[208:211], v[72:75]
    s_lshl_b32 s33, s41, 9
    s_add_u32 s33, s33, s3
    s_add_u32 s34, s32, 1024
    v_mfma_f32_16x16x32_bf16 v[96:99], a[156:159], a[208:211], v[96:99]
    s_add_u32 s35, s32, 1536
    s_add_u32 s36, s33, 10752
    s_cmp_eq_u32 s24, 3
    v_mfma_f32_16x16x32_bf16 v[52:55], a[44:47], a[212:215], v[52:55]
    s_cselect_b32 s34, s33, s34
    s_cselect_b32 s35, s36, s35
    v_mfma_f32_16x16x32_bf16 v[76:79], a[100:103], a[212:215], v[76:79]
    v_mfma_f32_16x16x32_bf16 v[100:103], a[156:159], a[212:215], v[100:103]
    s_waitcnt lgkmcnt(0)
    v_mfma_f32_16x16x32_bf16 v[32:35], a[168:171], a[48:51], v[32:35]
    ds_read_b64_tr_b16 a[192:193], v8 offset:24832
    ds_read_b64_tr_b16 a[194:195], v8 offset:25088
    ds_read_b64_tr_b16 a[196:197], v9 offset:24832
    v_mfma_f32_16x16x32_bf16 v[56:59], a[168:171], a[104:107], v[56:59]
    ds_read_b64_tr_b16 a[198:199], v9 offset:25088
    ds_read_b64_tr_b16 a[200:201], v8 offset:26880
    ds_read_b64_tr_b16 a[202:203], v8 offset:27136
    v_mfma_f32_16x16x32_bf16 v[80:83], a[168:171], a[160:163], v[80:83]
    ds_read_b64_tr_b16 a[204:205], v9 offset:26880
    ds_read_b64_tr_b16 a[206:207], v9 offset:27136
    ds_read_b64_tr_b16 a[208:209], v8 offset:28928
    v_mfma_f32_16x16x32_bf16 v[36:39], a[172:175], a[48:51], v[36:39]
    ds_read_b64_tr_b16 a[210:211], v8 offset:29184
    ds_read_b64_tr_b16 a[212:213], v9 offset:28928
    ds_read_b64_tr_b16 a[214:215], v9 offset:29184
    v_mfma_f32_16x16x32_bf16 v[60:63], a[172:175], a[104:107], v[60:63]
    buffer_store_dwordx4 a[236:239], v4, s[96:99], s78 offen offset:1024 sc1
    v_lshlrev_b32 v10, 2, v3
    v_sub_u32 v10, v2, v10
    v_mfma_f32_16x16x32_bf16 v[84:87], a[172:175], a[160:163], v[84:87]
    v_add_u32 v11, 16, v10
    v_cmp_gt_u32 s[4:5], 8, v11
    v_subrev_u32 v11, 0, v10
    v_mfma_f32_16x16x32_bf16 v[40:43], a[176:179], a[48:51], v[40:43]
    v_cmp_gt_u32 s[18:19], 8, v11
    v_add_u32 v11, 15, v10
    v_cmp_gt_u32 s[6:7], 8, v11
    v_mfma_f32_16x16x32_bf16 v[64:67], a[176:179], a[104:107], v[64:67]
    v_subrev_u32 v11, 1, v10
    v_cmp_gt_u32 s[20:21], 8, v11
    v_add_u32 v11, 14, v10
    v_mfma_f32_16x16x32_bf16 v[88:91], a[176:179], a[160:163], v[88:91]
    v_cmp_gt_u32 s[8:9], 8, v11
    v_subrev_u32 v11, 2, v10
    v_cmp_gt_u32 s[22:23], 8, v11
    v_mfma_f32_16x16x32_bf16 v[44:47], a[180:183], a[48:51], v[44:47]
    v_add_u32 v11, 13, v10
    v_cmp_gt_u32 s[16:17], 8, v11
    v_subrev_u32 v11, 3, v10
    v_mfma_f32_16x16x32_bf16 v[68:71], a[180:183], a[104:107], v[68:71]
    v_cmp_gt_u32 s[64:65], 8, v11
    s_cmp_eq_u32 s31, 0
    s_cselect_b64 s[66:67], 0, s[4:5]
    s_cselect_b64 s[92:93], 0, s[6:7]
    s_cselect_b64 s[94:95], 0, s[8:9]
    s_cselect_b64 s[74:75], 0, s[16:17]
    s_waitcnt vmcnt(5)
    s_mov_b32 s47, 0
st_check:
    v_cmp_ne_u32 vcc, s72, v106
    s_mov_b32 s44, -1
    s_mov_b32 s45, 0xffff
    s_and_b64 vcc, vcc, s[44:45]
    s_add_u32 s47, s47, 1
    s_cmp_gt_u32 s47, 200000
    s_cbranch_scc1 st_ok
    s_cbranch_vccz st_ok
    s_lshr_b32 s38, s31, 1
    s_sub_u32 s38, s38, 16
    v_add_u32 v15, s38, v1
    v_max_i32 v15, 0, v15
    v_min_u32 v15, 1023, v15
    v_lshlrev_b32 v15, 4, v15
    s_lshl_b32 s39, s29, 14
    s_add_u32 s39, s39, 65536
    buffer_load_dwordx4 v[104:107], v15, s[52:55], s39 offen sc1
    s_waitcnt vmcnt(0)
    s_branch st_check
st_ok:
    v_mfma_f32_16x16x32_bf16 v[92:95], a[180:183], a[160:163], v[92:95]
    s_lshl_b32 s39, s24, 10
    s_add_u32 s39, s39, 0
    v_lshl_add_u32 v15, v1, 2, s39
    v_mfma_f32_16x16x32_bf16 v[48:51], a[48:51], a[184:187], v[48:51]
    ds_write2st64_b32 v15, v104, v105 offset0:0 offset1:1
    v_lshl_add_u32 v15, v2, 2, s39
    v_lshl_add_u32 v16, v3, 4, s39
    v_mfma_f32_16x16x32_bf16 v[72:75], a[104:107], a[184:187], v[72:75]
    v_mfma_f32_16x16x32_bf16 v[96:99], a[160:163], a[184:187], v[96:99]
    v_mfma_f32_16x16x32_bf16 v[52:55], a[48:51], a[188:191], v[52:55]
    v_mfma_f32_16x16x32_bf16 v[76:79], a[104:107], a[188:191], v[76:79]
    v_mfma_f32_16x16x32_bf16 v[100:103], a[160:163], a[188:191], v[100:103]
    s_waitcnt lgkmcnt(1)
    v_mfma_f32_16x16x32_bf16 v[32:35], a[192:195], a[52:55], v[32:35]
    s_mov_b64 exec, 0xff
    buffer_store_dwordx4 a[236:239], v4, s[96:99], s79 offen sc1
    s_mov_b64 exec, -1
    ds_read2_b32 v[104:105], v15 offset0:0 offset1:64
    ds_read_b128 v[116:119], v16 offset:0
    v_mfma_f32_16x16x32_bf16 v[56:59], a[192:195], a[108:111], v[56:59]
    ds_read_b128 v[120:123], v16 offset:256
    ds_read2_b32 v[108:109], v15 offset0:16 offset1:80
    ds_read_b128 v[124:127], v16 offset:64
    v_mfma_f32_16x16x32_bf16 v[80:83], a[192:195], a[164:167], v[80:83]
    ds_read_b128 v[128:131], v16 offset:320
    ds_read2_b32 v[112:113], v15 offset0:32 offset1:96
    ds_read_b128 v[132:135], v16 offset:128
    v_mfma_f32_16x16x32_bf16 v[36:39], a[196:199], a[52:55], v[36:39]
    ds_read_b128 v[136:139], v16 offset:384
    v_lshrrev_b32 v12, 2, v2
    v_lshl_add_u32 v13, v3, 3, v12
    v_mfma_f32_16x16x32_bf16 v[60:63], a[196:199], a[108:111], v[60:63]
    v_lshlrev_b32 v13, 7, v13
    v_and_b32 v8, 3, v2
    v_lshl_add_u32 v13, v8, 3, v13
    v_mfma_f32_16x16x32_bf16 v[84:87], a[196:199], a[164:167], v[84:87]
    v_add_u32 v13, 98304, v13
    v_lshrrev_b32 v12, 1, v12
    v_and_b32 v8, 1, v3
    v_mfma_f32_16x16x32_bf16 v[40:43], a[200:203], a[52:55], v[40:43]
    v_lshl_or_b32 v12, v8, 1, v12
    v_xor_b32 v8, 0, v12
    v_lshl_add_u32 v8, v8, 5, v13
    v_mfma_f32_16x16x32_bf16 v[64:67], a[200:203], a[108:111], v[64:67]
    v_xor_b32 v9, 1, v12
    v_lshl_add_u32 v9, v9, 5, v13
    v_xor_b32 v10, 2, v12
    v_mfma_f32_16x16x32_bf16 v[88:91], a[200:203], a[164:167], v[88:91]
    v_lshl_add_u32 v10, v10, 5, v13
    v_xor_b32 v11, 3, v12
    v_lshl_add_u32 v11, v11, 5, v13
    v_mfma_f32_16x16x32_bf16 v[44:47], a[204:207], a[52:55], v[44:47]
    v_mfma_f32_16x16x32_bf16 v[68:71], a[204:207], a[108:111], v[68:71]
    v_mfma_f32_16x16x32_bf16 v[92:95], a[204:207], a[164:167], v[92:95]
    v_mfma_f32_16x16x32_bf16 v[48:51], a[52:55], a[208:211], v[48:51]
    v_mfma_f32_16x16x32_bf16 v[72:75], a[108:111], a[208:211], v[72:75]
    v_mfma_f32_16x16x32_bf16 v[96:99], a[164:167], a[208:211], v[96:99]
    v_mfma_f32_16x16x32_bf16 v[52:55], a[52:55], a[212:215], v[52:55]
    v_mfma_f32_16x16x32_bf16 v[76:79], a[108:111], a[212:215], v[76:79]
    v_mfma_f32_16x16x32_bf16 v[100:103], a[164:167], a[212:215], v[100:103]
    s_waitcnt lgkmcnt(0)
    s_barrier
    v_lshlrev_b32 v12, 2, v2
    ds_bpermute_b32 v18, v12, v48
    ds_bpermute_b32 v19, v12, v49
    ds_read_b64_tr_b16 a[0:1], v8 offset:0
    ds_bpermute_b32 v20, v12, v52
    ds_bpermute_b32 v21, v12, v53
    v_mov_b32_dpp v212, v32 row_newbcast:0 row_mask:0xf bank_mask:0xf
    ds_read_b64_tr_b16 a[2:3], v8 offset:512
    v_mov_b32_dpp v228, v32 row_newbcast:1 row_mask:0xf bank_mask:0xf
    v_mov_b32_dpp v213, v33 row_newbcast:0 row_mask:0xf bank_mask:0xf
    v_mov_b32_dpp v229, v33 row_newbcast:1 row_mask:0xf bank_mask:0xf
    ds_read_b64_tr_b16 a[4:5], v9 offset:0
    v_mov_b32_dpp v214, v34 row_newbcast:0 row_mask:0xf bank_mask:0xf
    buffer_load_dwordx2 a[240:241], v244, s[52:55], s32 offen sc1
    v_mov_b32_dpp v230, v34 row_newbcast:1 row_mask:0xf bank_mask:0xf
    v_mov_b32_dpp v215, v35 row_newbcast:0 row_mask:0xf bank_mask:0xf
    ds_read_b64_tr_b16 a[6:7], v9 offset:512
    v_mov_b32_dpp v231, v35 row_newbcast:1 row_mask:0xf bank_mask:0xf
    v_mov_b32_dpp v216, v36 row_newbcast:0 row_mask:0xf bank_mask:0xf
    v_mov_b32_dpp v232, v36 row_newbcast:1 row_mask:0xf bank_mask:0xf
    ds_read_b64_tr_b16 a[8:9], v10 offset:0
    v_mov_b32_dpp v217, v37 row_newbcast:0 row_mask:0xf bank_mask:0xf
    v_mov_b32_dpp v233, v37 row_newbcast:1 row_mask:0xf bank_mask:0xf
    v_mov_b32_dpp v218, v38 row_newbcast:0 row_mask:0xf bank_mask:0xf
    ds_read_b64_tr_b16 a[10:11], v10 offset:512
    v_mov_b32_dpp v234, v38 row_newbcast:1 row_mask:0xf bank_mask:0xf
    v_mov_b32_dpp v219, v39 row_newbcast:0 row_mask:0xf bank_mask:0xf
    buffer_load_dwordx2 a[242:243], v244, s[52:55], s32 offen offset:512 sc1
    v_mov_b32_dpp v235, v39 row_newbcast:1 row_mask:0xf bank_mask:0xf
    ds_read_b64_tr_b16 a[12:13], v11 offset:0
    v_mov_b32_dpp v220, v40 row_newbcast:0 row_mask:0xf bank_mask:0xf
    v_mov_b32_dpp v236, v40 row_newbcast:1 row_mask:0xf bank_mask:0xf
    v_mov_b32_dpp v221, v41 row_newbcast:0 row_mask:0xf bank_mask:0xf
    ds_read_b64_tr_b16 a[14:15], v11 offset:512
    v_mov_b32_dpp v237, v41 row_newbcast:1 row_mask:0xf bank_mask:0xf
    v_mov_b32_dpp v222, v42 row_newbcast:0 row_mask:0xf bank_mask:0xf
    v_mov_b32_dpp v238, v42 row_newbcast:1 row_mask:0xf bank_mask:0xf
    ds_read_b64_tr_b16 a[16:17], v8 offset:4096
    v_mov_b32_dpp v223, v43 row_newbcast:0 row_mask:0xf bank_mask:0xf
    v_mov_b32_dpp v239, v43 row_newbcast:1 row_mask:0xf bank_mask:0xf
    v_mov_b32_dpp v224, v44 row_newbcast:0 row_mask:0xf bank_mask:0xf
    buffer_load_dwordx2 a[244:245], v244, s[52:55], s34 offen sc1
    ds_read_b64_tr_b16 a[18:19], v8 offset:4608
    v_mov_b32_dpp v240, v44 row_newbcast:1 row_mask:0xf bank_mask:0xf
    v_mov_b32_dpp v225, v45 row_newbcast:0 row_mask:0xf bank_mask:0xf
    v_mov_b32_dpp v241, v45 row_newbcast:1 row_mask:0xf bank_mask:0xf
    ds_read_b64_tr_b16 a[20:21], v9 offset:4096
    v_mov_b32_dpp v226, v46 row_newbcast:0 row_mask:0xf bank_mask:0xf
    v_mov_b32_dpp v242, v46 row_newbcast:1 row_mask:0xf bank_mask:0xf
    v_mov_b32_dpp v227, v47 row_newbcast:0 row_mask:0xf bank_mask:0xf
    s_waitcnt lgkmcnt(10)
    ds_read_b64_tr_b16 a[22:23], v9 offset:4608
    v_mov_b32_dpp v243, v47 row_newbcast:1 row_mask:0xf bank_mask:0xf
    v_pk_fma_f32 v[40:41], v[104:105], v[220:221], v[40:41] op_sel_hi:[0,1,1] neg_lo:[1,0,0] neg_hi:[1,0,0]
    v_pk_fma_f32 v[42:43], v[104:105], v[222:223], v[42:43] op_sel_hi:[0,1,1] neg_lo:[1,0,0] neg_hi:[1,0,0]
    ds_read_b64_tr_b16 a[24:25], v10 offset:4096
    buffer_load_dwordx2 a[246:247], v244, s[52:55], s35 offen sc1
    v_pk_fma_f32 v[44:45], v[104:105], v[224:225], v[44:45] op_sel_hi:[0,1,1] neg_lo:[1,0,0] neg_hi:[1,0,0]
    v_pk_fma_f32 v[46:47], v[104:105], v[226:227], v[46:47] op_sel_hi:[0,1,1] neg_lo:[1,0,0] neg_hi:[1,0,0]
    v_pk_fma_f32 v[40:41], v[104:105], v[40:41], v[236:237] op_sel:[1,0,0] op_sel_hi:[1,1,1]
    ds_read_b64_tr_b16 a[26:27], v10 offset:4608
    v_pk_fma_f32 v[42:43], v[104:105], v[42:43], v[238:239] op_sel:[1,0,0] op_sel_hi:[1,1,1]
    v_pk_fma_f32 v[44:45], v[104:105], v[44:45], v[240:241] op_sel:[1,0,0] op_sel_hi:[1,1,1]
    v_pk_fma_f32 v[46:47], v[104:105], v[46:47], v[242:243] op_sel:[1,0,0] op_sel_hi:[1,1,1]
    ds_read_b64_tr_b16 a[28:29], v11 offset:4096
    v_cvt_pk_bf16_f32 v172, v40, v41
    v_cvt_pk_bf16_f32 v173, v42, v43
    v_cvt_pk_bf16_f32 v174, v44, v45
    ds_read_b64_tr_b16 a[30:31], v11 offset:4608
    v_cvt_pk_bf16_f32 v175, v46, v47
    s_add_u32 m0, s89, 0
    s_mov_b32 s90, s88
    buffer_load_dwordx4 v24, s[56:59], s90 offen lds
    v_pk_fma_f32 v[56:57], v[108:109], v[212:213], v[56:57] op_sel_hi:[0,1,1] neg_lo:[1,0,0] neg_hi:[1,0,0]
    v_pk_fma_f32 v[58:59], v[108:109], v[214:215], v[58:59] op_sel_hi:[0,1,1] neg_lo:[1,0,0] neg_hi:[1,0,0]
    s_waitcnt lgkmcnt(10)
    ds_read_b64_tr_b16 a[32:33], v8 offset:8192
    v_pk_fma_f32 v[60:61], v[108:109], v[216:217], v[60:61] op_sel_hi:[0,1,1] neg_lo:[1,0,0] neg_hi:[1,0,0]
    v_pk_fma_f32 v[62:63], v[108:109], v[218:219], v[62:63] op_sel_hi:[0,1,1] neg_lo:[1,0,0] neg_hi:[1,0,0]
    v_pk_fma_f32 v[56:57], v[108:109], v[56:57], v[228:229] op_sel:[1,0,0] op_sel_hi:[1,1,1]
    ds_read_b64_tr_b16 a[34:35], v8 offset:8704
    v_pk_fma_f32 v[58:59], v[108:109], v[58:59], v[230:231] op_sel:[1,0,0] op_sel_hi:[1,1,1]
    v_pk_fma_f32 v[60:61], v[108:109], v[60:61], v[232:233] op_sel:[1,0,0] op_sel_hi:[1,1,1]
    v_pk_fma_f32 v[62:63], v[108:109], v[62:63], v[234:235] op_sel:[1,0,0] op_sel_hi:[1,1,1]
    ds_read_b64_tr_b16 a[36:37], v9 offset:8192
    v_cvt_pk_bf16_f32 v164, v56, v57
    v_cvt_pk_bf16_f32 v165, v58, v59
    buffer_load_dwordx4 v25, s[56:59], s90 offen offset:1024 lds
    v_cvt_pk_bf16_f32 v166, v60, v61
    ds_read_b64_tr_b16 a[38:39], v9 offset:8704
    v_cvt_pk_bf16_f32 v167, v62, v63
    v_cndmask_b32 v166, v166, 0, s[76:77]
    v_cndmask_b32 v167, v167, 0, s[76:77]
    ds_read_b64_tr_b16 a[40:41], v10 offset:8192
    v_pk_fma_f32 v[64:65], v[108:109], v[220:221], v[64:65] op_sel_hi:[0,1,1] neg_lo:[1,0,0] neg_hi:[1,0,0]
    v_pk_fma_f32 v[66:67], v[108:109], v[222:223], v[66:67] op_sel_hi:[0,1,1] neg_lo:[1,0,0] neg_hi:[1,0,0]
    v_pk_fma_f32 v[68:69], v[108:109], v[224:225], v[68:69] op_sel_hi:[0,1,1] neg_lo:[1,0,0] neg_hi:[1,0,0]
    s_waitcnt lgkmcnt(10)
    ds_read_b64_tr_b16 a[42:43], v10 offset:8704
    v_pk_fma_f32 v[70:71], v[108:109], v[226:227], v[70:71] op_sel_hi:[0,1,1] neg_lo:[1,0,0] neg_hi:[1,0,0]
    v_pk_fma_f32 v[64:65], v[108:109], v[64:65], v[236:237] op_sel:[1,0,0] op_sel_hi:[1,1,1]
    v_pk_fma_f32 v[66:67], v[108:109], v[66:67], v[238:239] op_sel:[1,0,0] op_sel_hi:[1,1,1]
    buffer_load_dwordx4 v26, s[56:59], s90 offen offset:2048 lds
    ds_read_b64_tr_b16 a[44:45], v11 offset:8192
    v_pk_fma_f32 v[68:69], v[108:109], v[68:69], v[240:241] op_sel:[1,0,0] op_sel_hi:[1,1,1]
    v_pk_fma_f32 v[70:71], v[108:109], v[70:71], v[242:243] op_sel:[1,0,0] op_sel_hi:[1,1,1]
    v_cvt_pk_bf16_f32 v176, v64, v65
    ds_read_b64_tr_b16 a[46:47], v11 offset:8704
    v_cvt_pk_bf16_f32 v177, v66, v67
    v_cvt_pk_bf16_f32 v178, v68, v69
    v_cvt_pk_bf16_f32 v179, v70, v71
    ds_read_b64_tr_b16 a[48:49], v8 offset:12288
    v_pk_fma_f32 v[80:81], v[112:113], v[212:213], v[80:81] op_sel_hi:[0,1,1] neg_lo:[1,0,0] neg_hi:[1,0,0]
    v_pk_fma_f32 v[82:83], v[112:113], v[214:215], v[82:83] op_sel_hi:[0,1,1] neg_lo:[1,0,0] neg_hi:[1,0,0]
    v_pk_fma_f32 v[84:85], v[112:113], v[216:217], v[84:85] op_sel_hi:[0,1,1] neg_lo:[1,0,0] neg_hi:[1,0,0]
    ds_read_b64_tr_b16 a[50:51], v8 offset:12800
    buffer_load_dwordx4 v27, s[56:59], s90 offen offset:3072 lds
    v_pk_fma_f32 v[86:87], v[112:113], v[218:219], v[86:87] op_sel_hi:[0,1,1] neg_lo:[1,0,0] neg_hi:[1,0,0]
    v_pk_fma_f32 v[80:81], v[112:113], v[80:81], v[228:229] op_sel:[1,0,0] op_sel_hi:[1,1,1]
    v_pk_fma_f32 v[82:83], v[112:113], v[82:83], v[230:231] op_sel:[1,0,0] op_sel_hi:[1,1,1]
    s_waitcnt lgkmcnt(10)
    ds_read_b64_tr_b16 a[52:53], v9 offset:12288
    v_pk_fma_f32 v[84:85], v[112:113], v[84:85], v[232:233] op_sel:[1,0,0] op_sel_hi:[1,1,1]
    v_pk_fma_f32 v[86:87], v[112:113], v[86:87], v[234:235] op_sel:[1,0,0] op_sel_hi:[1,1,1]
    v_cvt_pk_bf16_f32 v168, v80, v81
    ds_read_b64_tr_b16 a[54:55], v9 offset:12800
    v_cvt_pk_bf16_f32 v169, v82, v83
    v_cvt_pk_bf16_f32 v170, v84, v85
    v_cvt_pk_bf16_f32 v171, v86, v87
    ds_read_b64_tr_b16 a[56:57], v10 offset:12288
    v_cndmask_b32 v170, v170, 0, s[76:77]
    s_add_u32 m0, s89, 16384
    s_add_u32 s90, s90, s91
    buffer_load_dwordx4 v24, s[56:59], s90 offen lds
    v_cndmask_b32 v171, v171, 0, s[76:77]
    v_pk_fma_f32 v[88:89], v[112:113], v[220:221], v[88:89] op_sel_hi:[0,1,1] neg_lo:[1,0,0] neg_hi:[1,0,0]
    ds_read_b64_tr_b16 a[58:59], v10 offset:12800
    v_pk_fma_f32 v[90:91], v[112:113], v[222:223], v[90:91] op_sel_hi:[0,1,1] neg_lo:[1,0,0] neg_hi:[1,0,0]
    v_pk_fma_f32 v[92:93], v[112:113], v[224:225], v[92:93] op_sel_hi:[0,1,1] neg_lo:[1,0,0] neg_hi:[1,0,0]
    v_pk_fma_f32 v[94:95], v[112:113], v[226:227], v[94:95] op_sel_hi:[0,1,1] neg_lo:[1,0,0] neg_hi:[1,0,0]
    ds_read_b64_tr_b16 a[60:61], v11 offset:12288
    v_pk_fma_f32 v[88:89], v[112:113], v[88:89], v[236:237] op_sel:[1,0,0] op_sel_hi:[1,1,1]
    v_pk_fma_f32 v[90:91], v[112:113], v[90:91], v[238:239] op_sel:[1,0,0] op_sel_hi:[1,1,1]
    v_pk_fma_f32 v[92:93], v[112:113], v[92:93], v[240:241] op_sel:[1,0,0] op_sel_hi:[1,1,1]
    s_waitcnt lgkmcnt(10)
    ds_read_b64_tr_b16 a[62:63], v11 offset:12800
    v_pk_fma_f32 v[94:95], v[112:113], v[94:95], v[242:243] op_sel:[1,0,0] op_sel_hi:[1,1,1]
    v_cvt_pk_bf16_f32 v180, v88, v89
    buffer_load_dwordx4 v25, s[56:59], s90 offen offset:1024 lds
    v_cvt_pk_bf16_f32 v181, v90, v91
    ds_read_b64_tr_b16 a[64:65], v8 offset:16384
    v_cvt_pk_bf16_f32 v182, v92, v93
    v_cvt_pk_bf16_f32 v183, v94, v95
    v_mfma_f32_16x16x32_bf16 v[196:199], v[172:175], v[164:167], 0
    ds_read_b64_tr_b16 a[66:67], v8 offset:16896
    v_mfma_f32_16x16x32_bf16 v[200:203], v[176:179], v[164:167], 0
    v_mfma_f32_16x16x32_bf16 v[204:207], v[176:179], v[168:171], 0
    v_mfma_f32_16x16x32_bf16 v[208:211], v[180:183], v[168:171], 0
    ds_read_b64_tr_b16 a[68:69], v9 offset:16384
    s_waitcnt lgkmcnt(0)
    v_pk_fma_f32 v[48:49], v[116:117], v[18:19], v[48:49] op_sel_hi:[1,0,1] neg_lo:[1,0,0] neg_hi:[1,0,0]
    v_pk_fma_f32 v[50:51], v[118:119], v[18:19], v[50:51] op_sel_hi:[1,0,1] neg_lo:[1,0,0] neg_hi:[1,0,0]
    buffer_load_dwordx4 v26, s[56:59], s90 offen offset:2048 lds
    ds_read_b64_tr_b16 a[70:71], v9 offset:16896
    v_pk_fma_f32 v[52:53], v[116:117], v[20:21], v[52:53] op_sel_hi:[1,0,1] neg_lo:[1,0,0] neg_hi:[1,0,0]
    v_pk_fma_f32 v[54:55], v[118:119], v[20:21], v[54:55] op_sel_hi:[1,0,1] neg_lo:[1,0,0] neg_hi:[1,0,0]
    v_pk_fma_f32 v[48:49], v[120:121], v[48:49], v[18:19] op_sel:[0,0,1] op_sel_hi:[1,1,1]
    ds_read_b64_tr_b16 a[72:73], v10 offset:16384
    v_pk_fma_f32 v[50:51], v[122:123], v[50:51], v[18:19] op_sel:[0,0,1] op_sel_hi:[1,1,1]
    v_pk_fma_f32 v[52:53], v[120:121], v[52:53], v[20:21] op_sel:[0,0,1] op_sel_hi:[1,1,1]
    v_pk_fma_f32 v[54:55], v[122:123], v[54:55], v[20:21] op_sel:[0,0,1] op_sel_hi:[1,1,1]
    ds_read_b64_tr_b16 a[74:75], v10 offset:16896
    v_cvt_pk_bf16_f32 v184, v48, v49
    v_cvt_pk_bf16_f32 v185, v50, v51
    v_cvt_pk_bf16_f32 v190, v52, v53
    ds_read_b64_tr_b16 a[76:77], v11 offset:16384
    buffer_load_dwordx4 v27, s[56:59], s90 offen offset:3072 lds
    v_cvt_pk_bf16_f32 v191, v54, v55
    v_pk_fma_f32 v[72:73], v[124:125], v[18:19], v[72:73] op_sel_hi:[1,0,1] neg_lo:[1,0,0] neg_hi:[1,0,0]
    v_pk_fma_f32 v[74:75], v[126:127], v[18:19], v[74:75] op_sel_hi:[1,0,1] neg_lo:[1,0,0] neg_hi:[1,0,0]
    ds_read_b64_tr_b16 a[78:79], v11 offset:16896
    v_pk_fma_f32 v[76:77], v[124:125], v[20:21], v[76:77] op_sel_hi:[1,0,1] neg_lo:[1,0,0] neg_hi:[1,0,0]
    v_pk_fma_f32 v[78:79], v[126:127], v[20:21], v[78:79] op_sel_hi:[1,0,1] neg_lo:[1,0,0] neg_hi:[1,0,0]
    v_pk_fma_f32 v[72:73], v[128:129], v[72:73], v[18:19] op_sel:[0,0,1] op_sel_hi:[1,1,1]
    s_barrier
    v_pk_fma_f32 v[74:75], v[130:131], v[74:75], v[18:19] op_sel:[0,0,1] op_sel_hi:[1,1,1]
    v_pk_fma_f32 v[76:77], v[128:129], v[76:77], v[20:21] op_sel:[0,0,1] op_sel_hi:[1,1,1]
    v_pk_fma_f32 v[78:79], v[130:131], v[78:79], v[20:21] op_sel:[0,0,1] op_sel_hi:[1,1,1]
    ds_read_b64_tr_b16 a[80:81], v8 offset:20480
    v_cvt_pk_bf16_f32 v186, v72, v73
    s_add_u32 m0, s89, 32768
    s_add_u32 s90, s90, s91
    buffer_load_dwordx4 v24, s[56:59], s90 offen lds
    v_cvt_pk_bf16_f32 v187, v74, v75
    v_cvt_pk_bf16_f32 v192, v76, v77
    ds_read_b64_tr_b16 a[82:83], v8 offset:20992
    v_cvt_pk_bf16_f32 v193, v78, v79
    v_pk_fma_f32 v[96:97], v[132:133], v[18:19], v[96:97] op_sel_hi:[1,0,1] neg_lo:[1,0,0] neg_hi:[1,0,0]
    v_pk_fma_f32 v[98:99], v[134:135], v[18:19], v[98:99] op_sel_hi:[1,0,1] neg_lo:[1,0,0] neg_hi:[1,0,0]
    ds_read_b64_tr_b16 a[84:85], v9 offset:20480
    v_pk_fma_f32 v[100:101], v[132:133], v[20:21], v[100:101] op_sel_hi:[1,0,1] neg_lo:[1,0,0] neg_hi:[1,0,0]
    v_pk_fma_f32 v[102:103], v[134:135], v[20:21], v[102:103] op_sel_hi:[1,0,1] neg_lo:[1,0,0] neg_hi:[1,0,0]
    v_pk_fma_f32 v[96:97], v[136:137], v[96:97], v[18:19] op_sel:[0,0,1] op_sel_hi:[1,1,1]
    ds_read_b64_tr_b16 a[86:87], v9 offset:20992
    v_pk_fma_f32 v[98:99], v[138:139], v[98:99], v[18:19] op_sel:[0,0,1] op_sel_hi:[1,1,1]
    v_pk_fma_f32 v[100:101], v[136:137], v[100:101], v[20:21] op_sel:[0,0,1] op_sel_hi:[1,1,1]
    buffer_load_dwordx4 v25, s[56:59], s90 offen offset:1024 lds
    v_pk_fma_f32 v[102:103], v[138:139], v[102:103], v[20:21] op_sel:[0,0,1] op_sel_hi:[1,1,1]
    ds_read_b64_tr_b16 a[88:89], v10 offset:20480
    v_cvt_pk_bf16_f32 v188, v96, v97
    v_cvt_pk_bf16_f32 v189, v98, v99
    v_cvt_pk_bf16_f32 v194, v100, v101
    ds_read_b64_tr_b16 a[90:91], v10 offset:20992
    v_cvt_pk_bf16_f32 v195, v102, v103
    s_mov_b32 s44, 0x3e41848f
    s_mov_b32 s45, 0x3e41848f
    ds_read_b64_tr_b16 a[92:93], v11 offset:20480
    s_mov_b32 s46, 0x3fb8aa3b
    s_mov_b32 s47, 0x3fb8aa3b
    v_mov_b32 v13, 0xce6e6b28
    buffer_load_dwordx4 v26, s[56:59], s90 offen offset:2048 lds
    ds_read_b64_tr_b16 a[94:95], v11 offset:20992
    v_cvt_pk_bf16_f32 v104, v196, v197
    v_cvt_pk_bf16_f32 v108, v204, v205
    v_cvt_pk_bf16_f32 v105, v198, v199
    ds_read_b64_tr_b16 a[96:97], v8 offset:24576
    v_cvt_pk_bf16_f32 v109, v206, v207
    v_cvt_pk_bf16_f32 v106, v200, v201
    v_cvt_pk_bf16_f32 v110, v208, v209
    ds_read_b64_tr_b16 a[98:99], v8 offset:25088
    v_cvt_pk_bf16_f32 v107, v202, v203
    v_cvt_pk_bf16_f32 v111, v210, v211
    v_lshlrev_b32 v196, 16, v104
    s_waitcnt lgkmcnt(10)
    ds_read_b64_tr_b16 a[100:101], v9 offset:24576
    buffer_load_dwordx4 v27, s[56:59], s90 offen offset:3072 lds
    v_lshlrev_b32 v204, 16, v108
    v_and_b32 v197, 0xffff0000, v104
    v_and_b32 v205, 0xffff0000, v108
    ds_read_b64_tr_b16 a[102:103], v9 offset:25088
    v_lshlrev_b32 v198, 16, v105
    v_lshlrev_b32 v206, 16, v109
    v_and_b32 v199, 0xffff0000, v105
    ds_read_b64_tr_b16 a[104:105], v10 offset:24576
    v_and_b32 v207, 0xffff0000, v109
    v_lshlrev_b32 v200, 16, v106
    v_lshlrev_b32 v208, 16, v110
    ds_read_b64_tr_b16 a[106:107], v10 offset:25088
    v_and_b32 v201, 0xffff0000, v106
    s_add_u32 m0, s89, 49152
    s_add_u32 s90, s90, s91
    buffer_load_dwordx4 v24, s[56:59], s90 offen lds
    v_and_b32 v209, 0xffff0000, v110
    v_lshlrev_b32 v202, 16, v107
    ds_read_b64_tr_b16 a[108:109], v11 offset:24576
    v_lshlrev_b32 v210, 16, v111
    v_and_b32 v203, 0xffff0000, v107
    v_and_b32 v211, 0xffff0000, v111
    s_waitcnt lgkmcnt(10)
    ds_read_b64_tr_b16 a[110:111], v11 offset:25088
    v_pk_mul_f32 v[196:197], s[44:45], v[196:197]
    v_pk_mul_f32 v[204:205], s[44:45], v[204:205]
    v_pk_mul_f32 v[198:199], s[44:45], v[198:199]
    ds_read_b64_tr_b16 a[112:113], v8 offset:28672
    v_pk_mul_f32 v[206:207], s[44:45], v[206:207]
    v_pk_mul_f32 v[200:201], s[44:45], v[200:201]
    buffer_load_dwordx4 v25, s[56:59], s90 offen offset:1024 lds
    v_pk_mul_f32 v[208:209], s[44:45], v[208:209]
    ds_read_b64_tr_b16 a[114:115], v8 offset:29184
    v_pk_mul_f32 v[202:203], s[44:45], v[202:203]
    v_pk_mul_f32 v[210:211], s[44:45], v[210:211]
    v_cvt_pk_bf16_f32 v104, v196, v197
    ds_read_b64_tr_b16 a[116:117], v9 offset:28672
    v_cvt_pk_bf16_f32 v108, v204, v205
    v_cvt_pk_bf16_f32 v105, v198, v199
    v_cvt_pk_bf16_f32 v109, v206, v207
    ds_read_b64_tr_b16 a[118:119], v9 offset:29184
    v_cvt_pk_bf16_f32 v106, v200, v201
    v_cvt_pk_bf16_f32 v110, v208, v209
    v_cvt_pk_bf16_f32 v107, v202, v203
    buffer_load_dwordx4 v26, s[56:59], s90 offen offset:2048 lds
    s_waitcnt lgkmcnt(10)
    ds_read_b64_tr_b16 a[120:121], v10 offset:28672
    v_cvt_pk_bf16_f32 v111, v210, v211
    v_lshlrev_b32 v196, 16, v104
    v_lshlrev_b32 v204, 16, v108
    ds_read_b64_tr_b16 a[122:123], v10 offset:29184
    v_and_b32 v197, 0xffff0000, v104
    v_and_b32 v205, 0xffff0000, v108
    v_lshlrev_b32 v198, 16, v105
    ds_read_b64_tr_b16 a[124:125], v11 offset:28672
    v_lshlrev_b32 v206, 16, v109
    v_and_b32 v199, 0xffff0000, v105
    v_and_b32 v207, 0xffff0000, v109
    ds_read_b64_tr_b16 a[126:127], v11 offset:29184
    buffer_load_dwordx4 v27, s[56:59], s90 offen offset:3072 lds
    v_lshlrev_b32 v200, 16, v106
    v_lshlrev_b32 v208, 16, v110
    v_and_b32 v201, 0xffff0000, v106
    ds_read_b64_tr_b16 a[128:129], v8 offset:32768
    v_and_b32 v209, 0xffff0000, v110
    v_lshlrev_b32 v202, 16, v107
    v_lshlrev_b32 v210, 16, v111
    s_waitcnt lgkmcnt(10)
    ds_read_b64_tr_b16 a[130:131], v8 offset:33280
    v_and_b32 v203, 0xffff0000, v107
    v_and_b32 v211, 0xffff0000, v111
    v_cndmask_b32 v196, v13, v196, s[66:67]
    ds_read_b64_tr_b16 a[132:133], v9 offset:32768
    v_cndmask_b32 v204, v13, v204, s[4:5]
    s_cmp_ge_u32 s28, 14
    s_cselect_b32 s58, 0, s58
    s_add_u32 m0, s89, 65536
    s_add_u32 s90, s90, s91
    buffer_load_dwordx4 v24, s[56:59], s90 offen lds
    v_cndmask_b32 v197, v13, v197, s[92:93]
    v_cndmask_b32 v205, v13, v205, s[6:7]
    ds_read_b64_tr_b16 a[134:135], v9 offset:33280
    v_cndmask_b32 v198, v13, v198, s[94:95]
    v_cndmask_b32 v206, v13, v206, s[8:9]
    v_cndmask_b32 v199, v13, v199, s[74:75]
    ds_read_b64_tr_b16 a[136:137], v10 offset:32768
    v_cndmask_b32 v207, v13, v207, s[16:17]
    v_cndmask_b32 v200, v13, v200, s[18:19]
    v_cndmask_b32 v208, v13, v208, s[18:19]
    ds_read_b64_tr_b16 a[138:139], v10 offset:33280
    v_cndmask_b32 v201, v13, v201, s[20:21]
    v_cndmask_b32 v209, v13, v209, s[20:21]
    buffer_load_dwordx4 v25, s[56:59], s90 offen offset:1024 lds
    v_cndmask_b32 v202, v13, v202, s[22:23]
    s_waitcnt lgkmcnt(10)
    ds_read_b64_tr_b16 a[140:141], v11 offset:32768
    v_cndmask_b32 v210, v13, v210, s[22:23]
    v_cndmask_b32 v203, v13, v203, s[64:65]
    v_cndmask_b32 v211, v13, v211, s[64:65]
    ds_read_b64_tr_b16 a[142:143], v11 offset:33280
    v_max3_f32 v104, v196, v197, v198
    v_max3_f32 v108, v204, v205, v206
    v_max3_f32 v105, v199, v200, v201
    ds_read_b64_tr_b16 a[144:145], v8 offset:36864
    v_max3_f32 v109, v207, v208, v209
    v_max3_f32 v104, v104, v202, v203
    v_max3_f32 v108, v108, v210, v211
    buffer_load_dwordx4 v26, s[56:59], s90 offen offset:2048 lds
    ds_read_b64_tr_b16 a[146:147], v8 offset:37376
    v_max_f32 v104, v104, v105
    v_max_f32 v108, v108, v109
    v_mov_b32 v105, v104
    ds_read_b64_tr_b16 a[148:149], v9 offset:36864
    v_mov_b32 v109, v108
    v_permlane16_swap_b32 v104, v105
    s_nop 0
    v_permlane16_swap_b32 v108, v109
    s_waitcnt lgkmcnt(10)
    ds_read_b64_tr_b16 a[150:151], v9 offset:37376
    v_max_f32 v104, v104, v105
    v_max_f32 v108, v108, v109
    v_mov_b32 v105, v104
    ds_read_b64_tr_b16 a[152:153], v10 offset:36864
    buffer_load_dwordx4 v27, s[56:59], s90 offen offset:3072 lds
    v_mov_b32 v109, v108
    v_permlane32_swap_b32 v104, v105
    s_nop 0
    v_permlane32_swap_b32 v108, v109
    ds_read_b64_tr_b16 a[154:155], v10 offset:37376
    v_max_f32 v104, v104, v105
    v_max_f32 v108, v108, v109
    v_pk_add_f32 v[196:197], v[196:197], v[104:105] op_sel_hi:[1,0] neg_lo:[0,1] neg_hi:[0,1]
    ds_read_b64_tr_b16 a[156:157], v11 offset:36864
    v_pk_add_f32 v[204:205], v[204:205], v[108:109] op_sel_hi:[1,0] neg_lo:[0,1] neg_hi:[0,1]
    v_pk_add_f32 v[198:199], v[198:199], v[104:105] op_sel_hi:[1,0] neg_lo:[0,1] neg_hi:[0,1]
    v_pk_add_f32 v[206:207], v[206:207], v[108:109] op_sel_hi:[1,0] neg_lo:[0,1] neg_hi:[0,1]
    ds_read_b64_tr_b16 a[158:159], v11 offset:37376
    v_pk_add_f32 v[200:201], v[200:201], v[104:105] op_sel_hi:[1,0] neg_lo:[0,1] neg_hi:[0,1]
    s_add_u32 m0, s89, 81920
    s_add_u32 s90, s90, s91
    buffer_load_dwordx4 v24, s[56:59], s90 offen lds
    v_pk_add_f32 v[208:209], v[208:209], v[108:109] op_sel_hi:[1,0] neg_lo:[0,1] neg_hi:[0,1]
    v_pk_add_f32 v[202:203], v[202:203], v[104:105] op_sel_hi:[1,0] neg_lo:[0,1] neg_hi:[0,1]
    s_waitcnt lgkmcnt(10)
    ds_read_b64_tr_b16 a[160:161], v8 offset:40960
    v_pk_add_f32 v[210:211], v[210:211], v[108:109] op_sel_hi:[1,0] neg_lo:[0,1] neg_hi:[0,1]
    v_pk_mul_f32 v[196:197], s[46:47], v[196:197]
    v_pk_mul_f32 v[204:205], s[46:47], v[204:205]
    ds_read_b64_tr_b16 a[162:163], v8 offset:41472
    v_pk_mul_f32 v[198:199], s[46:47], v[198:199]
    v_pk_mul_f32 v[206:207], s[46:47], v[206:207]
    v_pk_mul_f32 v[200:201], s[46:47], v[200:201]
    ds_read_b64_tr_b16 a[164:165], v9 offset:40960
    v_pk_mul_f32 v[208:209], s[46:47], v[208:209]
    v_pk_mul_f32 v[202:203], s[46:47], v[202:203]
    buffer_load_dwordx4 v25, s[56:59], s90 offen offset:1024 lds
    v_pk_mul_f32 v[210:211], s[46:47], v[210:211]
    ds_read_b64_tr_b16 a[166:167], v9 offset:41472
    v_exp_f32 v196, v196
    v_exp_f32 v204, v204
    v_exp_f32 v197, v197
    ds_read_b64_tr_b16 a[168:169], v10 offset:40960
    v_exp_f32 v205, v205
    v_exp_f32 v198, v198
    v_exp_f32 v206, v206
    s_waitcnt lgkmcnt(10)
    ds_read_b64_tr_b16 a[170:171], v10 offset:41472
    v_exp_f32 v199, v199
    v_exp_f32 v207, v207
    v_exp_f32 v200, v200
    buffer_load_dwordx4 v26, s[56:59], s90 offen offset:2048 lds
    ds_read_b64_tr_b16 a[172:173], v11 offset:40960
    v_exp_f32 v208, v208
    v_exp_f32 v201, v201
    v_exp_f32 v209, v209
    ds_read_b64_tr_b16 a[174:175], v11 offset:41472
    v_exp_f32 v202, v202
    v_exp_f32 v210, v210
    v_exp_f32 v203, v203
    ds_read_b64_tr_b16 a[176:177], v8 offset:45056
    v_exp_f32 v211, v211
    v_add_f32 v104, v196, v197
    v_add_f32 v108, v204, v205
    ds_read_b64_tr_b16 a[178:179], v8 offset:45568
    buffer_load_dwordx4 v27, s[56:59], s90 offen offset:3072 lds
    v_add_f32 v105, v198, v199
    v_add_f32 v109, v206, v207
    v_add_f32 v106, v200, v201
    s_waitcnt lgkmcnt(10)
    ds_read_b64_tr_b16 a[180:181], v9 offset:45056
    v_add_f32 v110, v208, v209
    v_add_f32 v107, v202, v203
    v_add_f32 v111, v210, v211
    ds_read_b64_tr_b16 a[182:183], v9 offset:45568
    v_add_f32 v104, v104, v105
    v_add_f32 v108, v108, v109
    v_add_f32 v106, v106, v107
    ds_read_b64_tr_b16 a[184:185], v10 offset:45056
    v_add_f32 v110, v110, v111
    s_add_u32 m0, s89, 98304
    s_add_u32 s90, s90, s91
    buffer_load_dwordx4 v24, s[56:59], s90 offen lds
    v_add_f32 v104, v104, v106
    v_add_f32 v108, v108, v110
    ds_read_b64_tr_b16 a[186:187], v10 offset:45568
    v_mov_b32 v105, v104
    v_mov_b32 v109, v108
    s_nop 0
    v_permlane16_swap_b32 v104, v105
    ds_read_b64_tr_b16 a[188:189], v11 offset:45056
    v_permlane16_swap_b32 v108, v109
    v_add_f32 v104, v104, v105
    v_add_f32 v108, v108, v109
    s_waitcnt lgkmcnt(10)
    ds_read_b64_tr_b16 a[190:191], v11 offset:45568
    v_mov_b32 v105, v104
    v_mov_b32 v109, v108
    buffer_load_dwordx4 v25, s[56:59], s90 offen offset:1024 lds
    v_permlane32_swap_b32 v104, v105
    ds_read_b64_tr_b16 a[192:193], v8 offset:49152
    v_permlane32_swap_b32 v108, v109
    v_add_f32 v104, v104, v105
    v_add_f32 v108, v108, v109
    ds_read_b64_tr_b16 a[194:195], v8 offset:49664
    v_rcp_f32 v104, v104
    v_rcp_f32 v108, v108
    v_pk_mul_f32 v[196:197], v[196:197], v[104:105] op_sel_hi:[1,0]
    ds_read_b64_tr_b16 a[196:197], v9 offset:49152
    v_pk_mul_f32 v[204:205], v[204:205], v[108:109] op_sel_hi:[1,0]
    v_pk_mul_f32 v[198:199], v[198:199], v[104:105] op_sel_hi:[1,0]
    v_pk_mul_f32 v[206:207], v[206:207], v[108:109] op_sel_hi:[1,0]
    buffer_load_dwordx4 v26, s[56:59], s90 offen offset:2048 lds
    ds_read_b64_tr_b16 a[198:199], v9 offset:49664
    v_pk_mul_f32 v[200:201], v[200:201], v[104:105] op_sel_hi:[1,0]
    v_pk_mul_f32 v[208:209], v[208:209], v[108:109] op_sel_hi:[1,0]
    v_pk_mul_f32 v[202:203], v[202:203], v[104:105] op_sel_hi:[1,0]
    s_waitcnt lgkmcnt(10)
    ds_read_b64_tr_b16 a[200:201], v10 offset:49152
    v_pk_mul_f32 v[210:211], v[210:211], v[108:109] op_sel_hi:[1,0]
    v_cvt_pk_bf16_f32 v112, v196, v197
    v_cvt_pk_bf16_f32 v116, v204, v205
    ds_read_b64_tr_b16 a[202:203], v10 offset:49664
    v_cvt_pk_bf16_f32 v113, v198, v199
    v_cvt_pk_bf16_f32 v117, v206, v207
    v_cvt_pk_bf16_f32 v114, v200, v201
    ds_read_b64_tr_b16 a[204:205], v11 offset:49152
    buffer_load_dwordx4 v27, s[56:59], s90 offen offset:3072 lds
    v_cvt_pk_bf16_f32 v118, v208, v209
    v_cvt_pk_bf16_f32 v115, v202, v203
    v_cvt_pk_bf16_f32 v119, v210, v211
    ds_read_b64_tr_b16 a[206:207], v11 offset:49664
    v_mfma_f32_16x16x32_bf16 v[32:35], v[184:187], v[112:115], 0
    v_mfma_f32_16x16x32_bf16 v[40:43], v[186:189], v[116:119], 0
    v_mfma_f32_16x16x32_bf16 v[36:39], v[190:193], v[112:115], 0
    ds_read_b64_tr_b16 a[208:209], v8 offset:53248
    v_mfma_f32_16x16x32_bf16 v[44:47], v[192:195], v[116:119], 0
    s_nop 3
    v_cvt_pk_bf16_f32 v48, v32, v33
    v_cvt_pk_bf16_f32 v49, v34, v35
    s_waitcnt lgkmcnt(10)
    ds_read_b64_tr_b16 a[210:211], v8 offset:53760
    v_cvt_pk_bf16_f32 v50, v36, v37
    v_cvt_pk_bf16_f32 v51, v38, v39
    v_cndmask_b32 v50, v50, 0, s[76:77]
    ds_read_b64_tr_b16 a[212:213], v9 offset:53248
    v_cndmask_b32 v51, v51, 0, s[76:77]
    v_cvt_pk_bf16_f32 v52, v40, v41
    v_cvt_pk_bf16_f32 v53, v42, v43
    ds_read_b64_tr_b16 a[214:215], v9 offset:53760
    v_cvt_pk_bf16_f32 v54, v44, v45
    v_cvt_pk_bf16_f32 v55, v46, v47
    v_cndmask_b32 v54, v54, 0, s[76:77]
    ds_read_b64_tr_b16 a[216:217], v10 offset:53248
    v_cndmask_b32 v55, v55, 0, s[76:77]
    v_permlane16_swap_b32 v48, v50
    v_permlane16_swap_b32 v49, v51
    ds_read_b64_tr_b16 a[218:219], v10 offset:53760
    v_permlane16_swap_b32 v52, v54
    v_permlane16_swap_b32 v53, v55
    s_waitcnt lgkmcnt(10)
    ds_read_b64_tr_b16 a[220:221], v11 offset:53248
    ds_read_b64_tr_b16 a[222:223], v11 offset:53760
    s_waitcnt vmcnt(35)
    buffer_store_dwordx4 v[48:51], v14, s[52:55], s100 offen sc1
    buffer_store_dwordx4 v[52:55], v14, s[52:55], s101 offen sc1
    s_waitcnt vmcnt(30)
    s_waitcnt lgkmcnt(0)
    s_barrier
    s_cmp_lg_u32 s24, 0
    s_cbranch_scc1 nw0_5
    s_lshl_b32 s45, s28, 2
    s_add_u32 s44, s84, s45
    s_add_u32 s45, s72, 1
    v_mov_b32 v31, s45
    v_mov_b32 v30, 0
    s_mov_b64 exec, 1
    buffer_store_dword v31, v30, s[52:55], s44 offen offset:128 sc1
    s_mov_b64 exec, -1
nw0_5:
    s_cmp_lt_u32 s28, 14
    s_cbranch_scc1 p2_go
    s_waitcnt vmcnt(0)
    s_lshl_b32 s45, s28, 2
    s_add_u32 s45, s45, s24
    s_lshl_b32 s45, s45, 2
    s_add_u32 s44, s84, s45
    v_mov_b32 v31, s72
    v_mov_b32 v30, 0
    s_mov_b64 exec, 1
    buffer_store_dword v31, v30, s[52:55], s44 offen offset:768 sc1
    s_mov_b64 exec, -1
    s_cmp_ge_u32 s87, 28
    s_cbranch_scc1 no_w2f
    v_lshrrev_b32 v10, 2, v2
    v_lshl_add_u32 v11, v3, 3, v10
    v_lshlrev_b32 v11, 7, v11
    v_and_b32 v24, 3, v2
    v_lshl_add_u32 v11, v24, 3, v11
    v_add_u32 v11, s89, v11
    v_lshrrev_b32 v10, 1, v10
    v_and_b32 v24, 1, v3
    v_lshl_or_b32 v10, v24, 1, v10
    v_xor_b32 v24, 0, v10
    v_lshl_add_u32 v24, v24, 5, v11
    v_xor_b32 v25, 1, v10
    v_lshl_add_u32 v25, v25, 5, v11
    v_xor_b32 v26, 2, v10
    v_lshl_add_u32 v26, v26, 5, v11
    v_xor_b32 v27, 3, v10
    v_lshl_add_u32 v27, v27, 5, v11
    s_mul_i32 s36, s87, 14
    s_add_u32 s36, s36, s24
    s_lshl_b32 s36, s36, 12
    s_add_u32 s36, s36, 1048576
    ds_read_b64_tr_b16 v[32:33], v24 offset:0
    ds_read_b64_tr_b16 v[34:35], v24 offset:512
    ds_read_b64_tr_b16 v[36:37], v25 offset:0
    ds_read_b64_tr_b16 v[38:39], v25 offset:512
    ds_read_b64_tr_b16 v[40:41], v26 offset:0
    ds_read_b64_tr_b16 v[42:43], v26 offset:512
    ds_read_b64_tr_b16 v[44:45], v27 offset:0
    ds_read_b64_tr_b16 v[46:47], v27 offset:512
    s_add_u32 s39, s36, 0
    s_waitcnt lgkmcnt(0)
    buffer_store_dwordx4 v[32:35], v4, s[52:55], s39 offen offset:0 sc1
    buffer_store_dwordx4 v[36:39], v4, s[52:55], s39 offen offset:1024 sc1
    buffer_store_dwordx4 v[40:43], v4, s[52:55], s39 offen offset:2048 sc1
    buffer_store_dwordx4 v[44:47], v4, s[52:55], s39 offen offset:3072 sc1
    ds_read_b64_tr_b16 v[48:49], v24 offset:16384
    ds_read_b64_tr_b16 v[50:51], v24 offset:16896
    ds_read_b64_tr_b16 v[52:53], v25 offset:16384
    ds_read_b64_tr_b16 v[54:55], v25 offset:16896
    ds_read_b64_tr_b16 v[56:57], v26 offset:16384
    ds_read_b64_tr_b16 v[58:59], v26 offset:16896
    ds_read_b64_tr_b16 v[60:61], v27 offset:16384
    ds_read_b64_tr_b16 v[62:63], v27 offset:16896
    s_add_u32 s39, s36, 16384
    s_waitcnt lgkmcnt(0)
    buffer_store_dwordx4 v[48:51], v4, s[52:55], s39 offen offset:0 sc1
    buffer_store_dwordx4 v[52:55], v4, s[52:55], s39 offen offset:1024 sc1
    buffer_store_dwordx4 v[56:59], v4, s[52:55], s39 offen offset:2048 sc1
    buffer_store_dwordx4 v[60:63], v4, s[52:55], s39 offen offset:3072 sc1
    ds_read_b64_tr_b16 v[64:65], v24 offset:32768
    ds_read_b64_tr_b16 v[66:67], v24 offset:33280
    ds_read_b64_tr_b16 v[68:69], v25 offset:32768
    ds_read_b64_tr_b16 v[70:71], v25 offset:33280
    ds_read_b64_tr_b16 v[72:73], v26 offset:32768
    ds_read_b64_tr_b16 v[74:75], v26 offset:33280
    ds_read_b64_tr_b16 v[76:77], v27 offset:32768
    ds_read_b64_tr_b16 v[78:79], v27 offset:33280
    s_add_u32 s39, s36, 32768
    s_waitcnt lgkmcnt(0)
    buffer_store_dwordx4 v[64:67], v4, s[52:55], s39 offen offset:0 sc1
    buffer_store_dwordx4 v[68:71], v4, s[52:55], s39 offen offset:1024 sc1
    buffer_store_dwordx4 v[72:75], v4, s[52:55], s39 offen offset:2048 sc1
    buffer_store_dwordx4 v[76:79], v4, s[52:55], s39 offen offset:3072 sc1
    s_cmp_ge_u32 s24, 2
    s_cbranch_scc1 w2f_b
    ds_read_b64_tr_b16 v[80:81], v24 offset:49152
    ds_read_b64_tr_b16 v[82:83], v24 offset:49664
    ds_read_b64_tr_b16 v[84:85], v25 offset:49152
    ds_read_b64_tr_b16 v[86:87], v25 offset:49664
    ds_read_b64_tr_b16 v[88:89], v26 offset:49152
    ds_read_b64_tr_b16 v[90:91], v26 offset:49664
    ds_read_b64_tr_b16 v[92:93], v27 offset:49152
    ds_read_b64_tr_b16 v[94:95], v27 offset:49664
    s_add_u32 s39, s36, 49152
    s_waitcnt lgkmcnt(0)
    buffer_store_dwordx4 v[80:83], v4, s[52:55], s39 offen offset:0 sc1
    buffer_store_dwordx4 v[84:87], v4, s[52:55], s39 offen offset:1024 sc1
    buffer_store_dwordx4 v[88:91], v4, s[52:55], s39 offen offset:2048 sc1
    buffer_store_dwordx4 v[92:95], v4, s[52:55], s39 offen offset:3072 sc1
w2f_b:
    s_waitcnt vmcnt(0)
    s_barrier
    s_cmp_lg_u32 s24, 0
    s_cbranch_scc1 k_fin
    s_lshr_b32 s39, s87, 2
    s_lshl_b32 s39, s39, 7
    s_and_b32 s44, s87, 3
    s_lshl_b32 s44, s44, 2
    s_add_u32 s39, s39, s44
    s_add_u32 s39, s39, 40960
    s_mov_b64 exec, 1
    v_mov_b32 v31, s72
    v_mov_b32 v30, 0
    s_waitcnt vmcnt(0)
    buffer_store_dword v31, v30, s[52:55], s39 offen sc1
    s_mov_b64 exec, -1
    s_branch k_fin
no_w2f:
    s_cmp_lg_u32 s2, 255
    s_cbranch_scc1 k_fin
    s_cmp_lg_u32 s24, 0
    s_cbranch_scc1 k_fin
    s_mov_b32 s44, 34816
    v_lshlrev_b32 v30, 2, v1
    v_cmp_gt_u32 vcc, 64, v1
    s_nop 0
    s_mov_b64 exec, vcc
    s_mov_b32 s47, 0
poll_6:
    buffer_load_dwordx4 v[24:27], v4, s[52:55], s44 offen sc1
    s_add_u32 s47, s47, 1
    s_waitcnt vmcnt(0)
    v_xor_b32 v24, s72, v24
    v_xor_b32 v25, s72, v25
    v_xor_b32 v26, s72, v26
    v_xor_b32 v27, s72, v27
    v_or3_b32 v31, v24, v25, v26
    v_or_b32 v31, v31, v27
    v_cmp_ne_u32 vcc, 0, v31
    s_cmp_gt_u32 s47, 200000
    s_cbranch_scc1 pollx_7
    s_sleep 1
    s_cbranch_vccnz poll_6
pollx_7:
    s_mov_b64 exec, -1
    v_mov_b32 v31, s72
    v_mov_b32 v30, 0
    s_mov_b32 s44, 32768
    s_mov_b64 exec, 1
    buffer_store_dword v31, v30, s[52:55], s44 offen sc1
    s_mov_b64 exec, -1
    s_branch k_fin
p2_go:
    s_mov_b32 s47, 0
pv_chk:
    v_accvgpr_read_b32 v32, a240
    v_accvgpr_read_b32 v33, a241
    v_accvgpr_read_b32 v34, a242
    v_accvgpr_read_b32 v35, a243
    v_accvgpr_read_b32 v36, a244
    v_accvgpr_read_b32 v37, a245
    v_accvgpr_read_b32 v38, a246
    v_accvgpr_read_b32 v39, a247
    s_lshl_b32 s39, s24, 10
    s_add_u32 s39, s39, 118784
    v_lshl_add_u32 v12, v1, 2, s39
    s_lshl_b32 s39, s24, 9
    s_add_u32 s39, s39, 122880
    v_lshl_add_u32 v13, v1, 1, s39
    v_xor_b32 v33, s72, v33
    v_xor_b32 v35, s72, v35
    v_xor_b32 v37, s72, v37
    v_xor_b32 v39, s72, v39
    v_or3_b32 v33, v33, v35, v37
    v_or_b32 v33, v33, v39
    v_cmp_ne_u32 vcc, 0, v33
    s_add_u32 s47, s47, 1
    s_cmp_gt_u32 s47, 200000
    s_cbranch_scc1 pv_ok
    s_cbranch_vccz pv_ok
    buffer_load_dwordx2 a[240:241], v244, s[52:55], s32 offen sc1
    buffer_load_dwordx2 a[242:243], v244, s[52:55], s32 offen offset:512 sc1
    buffer_load_dwordx2 a[244:245], v244, s[52:55], s34 offen sc1
    buffer_load_dwordx2 a[246:247], v244, s[52:55], s35 offen sc1
    s_waitcnt vmcnt(0)
    s_branch pv_chk
pv_ok:
    ds_write_b32 v12, v32 offset:0
    ds_write_b16_d16_hi v13, v32 offset:0
    ds_write_b32 v12, v34 offset:256
    ds_write_b16_d16_hi v13, v34 offset:128
    ds_write_b32 v12, v36 offset:512
    ds_write_b16_d16_hi v13, v36 offset:256
    ds_write_b32 v12, v38 offset:768
    ds_write_b16_d16_hi v13, v38 offset:384
    s_lshl_b32 s36, s40, 2
    s_add_u32 s36, s36, s24
    s_lshl_b32 s78, s36, 14
    v_mov_b32 v18, v8
    v_mov_b32 v19, v9
    v_mov_b32 v20, v10
    v_mov_b32 v21, v11
    v_and_b32 v12, 1, v3
    v_lshrrev_b32 v13, 1, v3
    v_lshl_add_u32 v12, v12, 1, v13
    v_lshlrev_b32 v23, 5, v12
    s_mul_i32 s37, s36, 14336
    v_add_u32 v23, 118784, v23
    v_and_b32 v11, 1, v2
    v_xor_b32 v11, 1, v11
    v_mul_u32_u24 v11, 896, v11
    v_lshl_add_u32 v11, v3, 4, v11
    v_add_u32 v11, 122880, v11
    s_lshl_b32 s39, s42, 1
    v_add_u32 v15, s39, v23
    v_accvgpr_read_b32 v208, a224
    v_accvgpr_read_b32 v209, a225
    v_accvgpr_read_b32 v210, a226
    v_accvgpr_read_b32 v211, a227
    v_accvgpr_read_b32 v212, a228
    v_accvgpr_read_b32 v213, a229
    v_accvgpr_read_b32 v214, a230
    v_accvgpr_read_b32 v215, a231
    v_lshlrev_b32 v104, 16, v208
    v_and_b32 v105, 0xffff0000, v208
    v_lshlrev_b32 v106, 16, v209
    v_and_b32 v107, 0xffff0000, v209
    v_lshlrev_b32 v108, 16, v210
    v_and_b32 v109, 0xffff0000, v210
    v_lshlrev_b32 v110, 16, v211
    v_and_b32 v111, 0xffff0000, v211
    v_lshlrev_b32 v112, 16, v212
    v_and_b32 v113, 0xffff0000, v212
    v_lshlrev_b32 v114, 16, v213
    v_and_b32 v115, 0xffff0000, v213
    v_lshlrev_b32 v116, 16, v214
    v_and_b32 v117, 0xffff0000, v214
    v_lshlrev_b32 v118, 16, v215
    v_and_b32 v119, 0xffff0000, v215
    s_lshl_b32 s35, s41, 2
    s_add_u32 s35, s35, s24
    s_lshl_b32 s34, s41, 7
    s_lshl_b32 s45, s24, 2
    s_add_u32 s34, s34, s45
    s_add_u32 s34, s34, 40960
    s_mul_i32 s35, s35, 57344
    s_add_u32 s35, s35, 1048576
    s_lshl_b32 s87, s41, 1
    s_mov_b32 s87, 0
    s_lshl_b32 s86, s87, 12
    s_add_u32 s35, s35, s86
    s_sub_u32 s86, s35, 57344
    v_mov_b32 v244, 0
    v_lshrrev_b32 v8, 2, v2
    v_lshl_add_u32 v9, v3, 3, v8
    v_lshlrev_b32 v9, 8, v9
    v_and_b32 v10, 3, v2
    v_lshl_add_u32 v9, v10, 3, v9
    v_lshlrev_b32 v8, 1, v8
    v_xor_b32 v8, s24, v8
    v_lshl_add_u32 v24, v8, 5, v9
    v_add_u32 v25, 57344, v24
    v_xor_b32 v26, 128, v24
    v_xor_b32 v27, 128, v25
    v_lshlrev_b32 v28, 9, v2
    v_lshl_add_u32 v28, v3, 4, v28
    s_lshl_b32 s39, s24, 6
    s_add_u32 s39, s39, 114688
    v_add_u32 v28, s39, v28
    v_cmp_gt_u32 s[76:77], 2, v2
    s_waitcnt vmcnt(2) lgkmcnt(0)
    s_barrier
    ds_read_b128 v[136:139], v11 offset:0
    ds_read_b128 v[140:143], v11 offset:64
    ds_read_b128 v[144:147], v11 offset:128
    ds_read_b128 v[148:151], v11 offset:192
    ds_read_b128 v[152:155], v11 offset:256
    ds_read_b128 v[156:159], v11 offset:320
    ds_read_b128 v[160:163], v11 offset:384
    ds_read_b128 v[164:167], v11 offset:448
    ds_read_b128 v[168:171], v11 offset:512
    ds_read_b128 v[172:175], v11 offset:576
    s_waitcnt lgkmcnt(4)
    ds_read_b128 v[176:179], v11 offset:640
    ds_read_b128 v[180:183], v11 offset:704
    ds_read_b128 v[184:187], v11 offset:768
    ds_read_b128 v[188:191], v11 offset:832
    s_lshl_b32 s38, s24, 1
    v_xor_b32 v8, s24, v8
    v_lshlrev_b32 v28, 9, v2
    v_lshl_add_u32 v28, v3, 4, v28
    v_add_u32 v28, 114688, v28
    s_waitcnt lgkmcnt(0)
    v_xor_b32 v24, s38, v8
    v_lshl_add_u32 v24, v24, 5, v9
    v_add_u32 v25, 57344, v24
    s_lshl_b32 s39, s38, 6
    v_add_u32 v26, s39, v28
    s_add_u32 s38, s38, 1
    ds_read_b64_tr_b16 v[32:33], v24 offset:0
    ds_read_b64_tr_b16 v[34:35], v24 offset:1024
    ds_read_b64_tr_b16 v[36:37], v24 offset:8192
    ds_read_b64_tr_b16 v[38:39], v24 offset:9216
    ds_read_b64_tr_b16 v[40:41], v24 offset:16384
    ds_read_b64_tr_b16 v[42:43], v24 offset:17408
    ds_read_b64_tr_b16 v[44:45], v24 offset:24576
    ds_read_b64_tr_b16 v[46:47], v24 offset:25600
    ds_read_b64_tr_b16 v[48:49], v24 offset:32768
    ds_read_b64_tr_b16 v[50:51], v24 offset:33792
    ds_read_b64_tr_b16 v[52:53], v24 offset:40960
    ds_read_b64_tr_b16 v[54:55], v24 offset:41984
    s_waitcnt lgkmcnt(10)
    v_mfma_f32_16x16x32_bf16 v[88:91], v[32:35], v[136:139], 0
    ds_read_b64_tr_b16 v[56:57], v24 offset:49152
    ds_read_b64_tr_b16 v[58:59], v24 offset:50176
    s_waitcnt lgkmcnt(10)
    v_mfma_f32_16x16x32_bf16 v[88:91], v[36:39], v[140:143], v[88:91]
    ds_read_b64_tr_b16 v[60:61], v25 offset:0
    ds_read_b64_tr_b16 v[62:63], v25 offset:1024
    s_waitcnt lgkmcnt(10)
    v_mfma_f32_16x16x32_bf16 v[88:91], v[40:43], v[144:147], v[88:91]
    ds_read_b64_tr_b16 v[64:65], v25 offset:8192
    ds_read_b64_tr_b16 v[66:67], v25 offset:9216
    s_waitcnt lgkmcnt(10)
    v_mfma_f32_16x16x32_bf16 v[88:91], v[44:47], v[148:151], v[88:91]
    ds_read_b64_tr_b16 v[68:69], v25 offset:16384
    ds_read_b64_tr_b16 v[70:71], v25 offset:17408
    s_waitcnt lgkmcnt(10)
    v_mfma_f32_16x16x32_bf16 v[88:91], v[48:51], v[152:155], v[88:91]
    ds_read_b64_tr_b16 v[72:73], v25 offset:24576
    ds_read_b64_tr_b16 v[74:75], v25 offset:25600
    s_waitcnt lgkmcnt(10)
    v_mfma_f32_16x16x32_bf16 v[88:91], v[52:55], v[156:159], v[88:91]
    ds_read_b64_tr_b16 v[76:77], v25 offset:32768
    ds_read_b64_tr_b16 v[78:79], v25 offset:33792
    s_waitcnt lgkmcnt(10)
    v_mfma_f32_16x16x32_bf16 v[88:91], v[56:59], v[160:163], v[88:91]
    ds_read_b64_tr_b16 v[80:81], v25 offset:40960
    ds_read_b64_tr_b16 v[82:83], v25 offset:41984
    s_waitcnt lgkmcnt(10)
    v_mfma_f32_16x16x32_bf16 v[88:91], v[60:63], v[164:167], v[88:91]
    ds_read_b64_tr_b16 v[84:85], v25 offset:49152
    ds_read_b64_tr_b16 v[86:87], v25 offset:50176
    s_waitcnt lgkmcnt(10)
    v_mfma_f32_16x16x32_bf16 v[88:91], v[64:67], v[168:171], v[88:91]
    s_waitcnt lgkmcnt(8)
    v_mfma_f32_16x16x32_bf16 v[88:91], v[68:71], v[172:175], v[88:91]
    s_waitcnt lgkmcnt(6)
    v_mfma_f32_16x16x32_bf16 v[88:91], v[72:75], v[176:179], v[88:91]
    s_waitcnt lgkmcnt(4)
    v_mfma_f32_16x16x32_bf16 v[88:91], v[76:79], v[180:183], v[88:91]
    s_waitcnt lgkmcnt(2)
    v_mfma_f32_16x16x32_bf16 v[88:91], v[80:83], v[184:187], v[88:91]
    s_waitcnt lgkmcnt(0)
    v_mfma_f32_16x16x32_bf16 v[88:91], v[84:87], v[188:191], v[88:91]
    s_mov_b64 exec, s[76:77]
    s_nop 6
    ds_write_b128 v26, v[88:91]
    s_mov_b64 exec, -1
    s_waitcnt lgkmcnt(0)
    v_xor_b32 v24, s38, v8
    v_lshl_add_u32 v24, v24, 5, v9
    v_add_u32 v25, 57344, v24
    s_lshl_b32 s39, s38, 6
    v_add_u32 v26, s39, v28
    s_add_u32 s38, s38, 1
    ds_read_b64_tr_b16 v[32:33], v24 offset:0
    ds_read_b64_tr_b16 v[34:35], v24 offset:1024
    ds_read_b64_tr_b16 v[36:37], v24 offset:8192
    ds_read_b64_tr_b16 v[38:39], v24 offset:9216
    ds_read_b64_tr_b16 v[40:41], v24 offset:16384
    ds_read_b64_tr_b16 v[42:43], v24 offset:17408
    ds_read_b64_tr_b16 v[44:45], v24 offset:24576
    ds_read_b64_tr_b16 v[46:47], v24 offset:25600
    ds_read_b64_tr_b16 v[48:49], v24 offset:32768
    ds_read_b64_tr_b16 v[50:51], v24 offset:33792
    ds_read_b64_tr_b16 v[52:53], v24 offset:40960
    ds_read_b64_tr_b16 v[54:55], v24 offset:41984
    s_waitcnt lgkmcnt(10)
    v_mfma_f32_16x16x32_bf16 v[88:91], v[32:35], v[136:139], 0
    ds_read_b64_tr_b16 v[56:57], v24 offset:49152
    ds_read_b64_tr_b16 v[58:59], v24 offset:50176
    s_waitcnt lgkmcnt(10)
    v_mfma_f32_16x16x32_bf16 v[88:91], v[36:39], v[140:143], v[88:91]
    ds_read_b64_tr_b16 v[60:61], v25 offset:0
    ds_read_b64_tr_b16 v[62:63], v25 offset:1024
    s_waitcnt lgkmcnt(10)
    v_mfma_f32_16x16x32_bf16 v[88:91], v[40:43], v[144:147], v[88:91]
    ds_read_b64_tr_b16 v[64:65], v25 offset:8192
    ds_read_b64_tr_b16 v[66:67], v25 offset:9216
    s_waitcnt lgkmcnt(10)
    v_mfma_f32_16x16x32_bf16 v[88:91], v[44:47], v[148:151], v[88:91]
    ds_read_b64_tr_b16 v[68:69], v25 offset:16384
    ds_read_b64_tr_b16 v[70:71], v25 offset:17408
    s_waitcnt lgkmcnt(10)
    v_mfma_f32_16x16x32_bf16 v[88:91], v[48:51], v[152:155], v[88:91]
    ds_read_b64_tr_b16 v[72:73], v25 offset:24576
    ds_read_b64_tr_b16 v[74:75], v25 offset:25600
    s_waitcnt lgkmcnt(10)
    v_mfma_f32_16x16x32_bf16 v[88:91], v[52:55], v[156:159], v[88:91]
    ds_read_b64_tr_b16 v[76:77], v25 offset:32768
    ds_read_b64_tr_b16 v[78:79], v25 offset:33792
    s_waitcnt lgkmcnt(10)
    v_mfma_f32_16x16x32_bf16 v[88:91], v[56:59], v[160:163], v[88:91]
    ds_read_b64_tr_b16 v[80:81], v25 offset:40960
    ds_read_b64_tr_b16 v[82:83], v25 offset:41984
    s_waitcnt lgkmcnt(10)
    v_mfma_f32_16x16x32_bf16 v[88:91], v[60:63], v[164:167], v[88:91]
    ds_read_b64_tr_b16 v[84:85], v25 offset:49152
    ds_read_b64_tr_b16 v[86:87], v25 offset:50176
    s_waitcnt lgkmcnt(10)
    v_mfma_f32_16x16x32_bf16 v[88:91], v[64:67], v[168:171], v[88:91]
    s_waitcnt lgkmcnt(8)
    v_mfma_f32_16x16x32_bf16 v[88:91], v[68:71], v[172:175], v[88:91]
    s_waitcnt lgkmcnt(6)
    v_mfma_f32_16x16x32_bf16 v[88:91], v[72:75], v[176:179], v[88:91]
    s_waitcnt lgkmcnt(4)
    v_mfma_f32_16x16x32_bf16 v[88:91], v[76:79], v[180:183], v[88:91]
    s_waitcnt lgkmcnt(2)
    v_mfma_f32_16x16x32_bf16 v[88:91], v[80:83], v[184:187], v[88:91]
    s_waitcnt lgkmcnt(0)
    v_mfma_f32_16x16x32_bf16 v[88:91], v[84:87], v[188:191], v[88:91]
    s_mov_b64 exec, s[76:77]
    s_nop 6
    ds_write_b128 v26, v[88:91]
    s_mov_b64 exec, -1
    s_waitcnt lgkmcnt(0)
pp_done:
    s_waitcnt lgkmcnt(0)
    s_cmp_lg_u32 s24, 0
    s_cbranch_scc1 nw0_8
    s_add_u32 s44, s84, 128
    s_add_u32 s45, s72, 1
    v_lshlrev_b32 v30, 2, v1
    v_cmp_gt_u32 vcc, 16, v1
    s_nop 0
    s_mov_b64 exec, vcc
    s_mov_b32 s47, 0
poll_9:
    buffer_load_dword v31, v30, s[52:55], s44 offen sc1
    s_add_u32 s47, s47, 1
    s_waitcnt vmcnt(0)
    v_cmp_ne_u32 vcc, s45, v31
    s_cmp_gt_u32 s47, 200000
    s_cbranch_scc1 pollx_10
    s_sleep 1
    s_cbranch_vccnz poll_9
pollx_10:
    s_mov_b64 exec, -1
nw0_8:
    s_barrier
p2_loads:
    s_add_u32 s79, s78, 3145728
    buffer_load_dwordx4 v[32:35], v4, s[52:55], s79 offen offset:0 sc1
    buffer_load_dwordx4 v[36:39], v4, s[52:55], s79 offen offset:1024 sc1
    buffer_load_dwordx4 v[40:43], v4, s[52:55], s79 offen offset:2048 sc1
    buffer_load_dwordx4 v[44:47], v4, s[52:55], s79 offen offset:3072 sc1
    s_add_u32 s79, s78, 3149824
    buffer_load_dwordx4 v[48:51], v4, s[52:55], s79 offen offset:0 sc1
    buffer_load_dwordx4 v[52:55], v4, s[52:55], s79 offen offset:1024 sc1
    buffer_load_dwordx4 v[56:59], v4, s[52:55], s79 offen offset:2048 sc1
    buffer_load_dwordx4 v[60:63], v4, s[52:55], s79 offen offset:3072 sc1
    s_add_u32 s79, s78, 3153920
    buffer_load_dwordx4 v[64:67], v4, s[52:55], s79 offen offset:0 sc1
    buffer_load_dwordx4 v[68:71], v4, s[52:55], s79 offen offset:1024 sc1
    buffer_load_dwordx4 v[72:75], v4, s[52:55], s79 offen offset:2048 sc1
    buffer_load_dwordx4 v[76:79], v4, s[52:55], s79 offen offset:3072 sc1
    s_add_u32 s79, s78, 3158016
    buffer_load_dwordx4 v[80:83], v4, s[52:55], s79 offen offset:0 sc1
    buffer_load_dwordx4 v[84:87], v4, s[52:55], s79 offen offset:1024 sc1
    buffer_load_dwordx4 v[120:123], v4, s[52:55], s79 offen offset:2048 sc1
    buffer_load_dwordx4 v[128:131], v4, s[52:55], s79 offen offset:3072 sc1
    ds_read_b128 v[216:219], v23 offset:3584
    ds_read_b128 v[220:223], v23 offset:3600
    ds_read_b128 v[224:227], v23 offset:3712
    ds_read_b128 v[228:231], v23 offset:3728
    ds_read_b128 v[232:235], v15 offset:1792
    ds_read_b128 v[236:239], v15 offset:1808
    ds_read_b128 v[240:243], v15 offset:1920
    ds_read_b128 v[132:135], v15 offset:1936
    ds_read_b64_tr_b16 a[224:225], v18 offset:57344
    ds_read_b64_tr_b16 a[226:227], v18 offset:57856
    ds_read_b64_tr_b16 a[228:229], v19 offset:57344
    ds_read_b64_tr_b16 a[230:231], v19 offset:57856
    ds_read_b64_tr_b16 a[232:233], v20 offset:57344
    ds_read_b64_tr_b16 a[234:235], v20 offset:57856
    ds_read_b64_tr_b16 a[236:237], v21 offset:57344
    s_waitcnt lgkmcnt(10)
    ds_read_b64_tr_b16 a[238:239], v21 offset:57856
    ds_read_b64_tr_b16 a[240:241], v18 offset:61440
    ds_read_b64_tr_b16 a[242:243], v18 offset:61952
    ds_read_b64_tr_b16 a[244:245], v19 offset:61440
    ds_read_b64_tr_b16 a[246:247], v19 offset:61952
    s_waitcnt lgkmcnt(10)
    ds_read_b64_tr_b16 a[248:249], v20 offset:61440
    ds_read_b64_tr_b16 a[250:251], v20 offset:61952
    ds_read_b64_tr_b16 a[252:253], v21 offset:61440
    ds_read_b64_tr_b16 a[254:255], v21 offset:61952
    s_waitcnt vmcnt(15)
    v_mfma_f32_16x16x32_bf16 v[88:91], a[0:3], v[32:35], 0
    v_mfma_f32_16x16x32_bf16 v[92:95], a[4:7], v[32:35], 0
    v_mfma_f32_16x16x32_bf16 v[96:99], a[8:11], v[32:35], 0
    v_mfma_f32_16x16x32_bf16 v[100:103], a[12:15], v[32:35], 0
    s_waitcnt vmcnt(14)
    v_mfma_f32_16x16x32_bf16 v[88:91], a[16:19], v[36:39], v[88:91]
    v_mfma_f32_16x16x32_bf16 v[92:95], a[20:23], v[36:39], v[92:95]
    v_mfma_f32_16x16x32_bf16 v[96:99], a[24:27], v[36:39], v[96:99]
    v_mfma_f32_16x16x32_bf16 v[100:103], a[28:31], v[36:39], v[100:103]
    s_lshl_b32 s45, s28, 2
    s_add_u32 s45, s45, s24
    s_lshl_b32 s45, s45, 2
    s_add_u32 s44, s84, s45
    v_mov_b32 v31, s72
    v_mov_b32 v30, 0
    s_mov_b64 exec, 1
    buffer_store_dword v31, v30, s[52:55], s44 offen offset:768 sc1
    s_mov_b64 exec, -1
    s_waitcnt vmcnt(14)
    v_mfma_f32_16x16x32_bf16 v[88:91], a[32:35], v[40:43], v[88:91]
    v_mfma_f32_16x16x32_bf16 v[92:95], a[36:39], v[40:43], v[92:95]
    v_mfma_f32_16x16x32_bf16 v[96:99], a[40:43], v[40:43], v[96:99]
    v_mfma_f32_16x16x32_bf16 v[100:103], a[44:47], v[40:43], v[100:103]
    s_waitcnt vmcnt(13)
    v_mfma_f32_16x16x32_bf16 v[88:91], a[48:51], v[44:47], v[88:91]
    v_mfma_f32_16x16x32_bf16 v[92:95], a[52:55], v[44:47], v[92:95]
    v_mfma_f32_16x16x32_bf16 v[96:99], a[56:59], v[44:47], v[96:99]
    v_mfma_f32_16x16x32_bf16 v[100:103], a[60:63], v[44:47], v[100:103]
    s_waitcnt vmcnt(12)
    v_mfma_f32_16x16x32_bf16 v[88:91], a[64:67], v[48:51], v[88:91]
    v_mfma_f32_16x16x32_bf16 v[92:95], a[68:71], v[48:51], v[92:95]
    v_mfma_f32_16x16x32_bf16 v[96:99], a[72:75], v[48:51], v[96:99]
    v_mfma_f32_16x16x32_bf16 v[100:103], a[76:79], v[48:51], v[100:103]
    s_waitcnt vmcnt(11)
    v_mfma_f32_16x16x32_bf16 v[88:91], a[80:83], v[52:55], v[88:91]
    v_mfma_f32_16x16x32_bf16 v[92:95], a[84:87], v[52:55], v[92:95]
    v_mfma_f32_16x16x32_bf16 v[96:99], a[88:91], v[52:55], v[96:99]
    v_mfma_f32_16x16x32_bf16 v[100:103], a[92:95], v[52:55], v[100:103]
    s_waitcnt vmcnt(10)
    v_mfma_f32_16x16x32_bf16 v[88:91], a[96:99], v[56:59], v[88:91]
    v_mfma_f32_16x16x32_bf16 v[92:95], a[100:103], v[56:59], v[92:95]
    v_mfma_f32_16x16x32_bf16 v[96:99], a[104:107], v[56:59], v[96:99]
    v_mfma_f32_16x16x32_bf16 v[100:103], a[108:111], v[56:59], v[100:103]
    s_waitcnt vmcnt(9)
    v_mfma_f32_16x16x32_bf16 v[88:91], a[112:115], v[60:63], v[88:91]
    v_mfma_f32_16x16x32_bf16 v[92:95], a[116:119], v[60:63], v[92:95]
    v_mfma_f32_16x16x32_bf16 v[96:99], a[120:123], v[60:63], v[96:99]
    v_mfma_f32_16x16x32_bf16 v[100:103], a[124:127], v[60:63], v[100:103]
    s_waitcnt vmcnt(8)
    v_mfma_f32_16x16x32_bf16 v[88:91], a[128:131], v[64:67], v[88:91]
    v_mfma_f32_16x16x32_bf16 v[92:95], a[132:135], v[64:67], v[92:95]
    v_mfma_f32_16x16x32_bf16 v[96:99], a[136:139], v[64:67], v[96:99]
    v_mfma_f32_16x16x32_bf16 v[100:103], a[140:143], v[64:67], v[100:103]
    s_waitcnt vmcnt(7)
    v_mfma_f32_16x16x32_bf16 v[88:91], a[144:147], v[68:71], v[88:91]
    v_mfma_f32_16x16x32_bf16 v[92:95], a[148:151], v[68:71], v[92:95]
    v_mfma_f32_16x16x32_bf16 v[96:99], a[152:155], v[68:71], v[96:99]
    v_mfma_f32_16x16x32_bf16 v[100:103], a[156:159], v[68:71], v[100:103]
    s_waitcnt vmcnt(6)
    v_mfma_f32_16x16x32_bf16 v[88:91], a[160:163], v[72:75], v[88:91]
    v_mfma_f32_16x16x32_bf16 v[92:95], a[164:167], v[72:75], v[92:95]
    v_mfma_f32_16x16x32_bf16 v[96:99], a[168:171], v[72:75], v[96:99]
    v_mfma_f32_16x16x32_bf16 v[100:103], a[172:175], v[72:75], v[100:103]
    s_waitcnt vmcnt(5)
    v_mfma_f32_16x16x32_bf16 v[88:91], a[176:179], v[76:79], v[88:91]
    v_mfma_f32_16x16x32_bf16 v[92:95], a[180:183], v[76:79], v[92:95]
    v_mfma_f32_16x16x32_bf16 v[96:99], a[184:187], v[76:79], v[96:99]
    v_mfma_f32_16x16x32_bf16 v[100:103], a[188:191], v[76:79], v[100:103]
    s_waitcnt vmcnt(4)
    v_mfma_f32_16x16x32_bf16 v[88:91], a[192:195], v[80:83], v[88:91]
    v_mfma_f32_16x16x32_bf16 v[92:95], a[196:199], v[80:83], v[92:95]
    v_mfma_f32_16x16x32_bf16 v[96:99], a[200:203], v[80:83], v[96:99]
    v_mfma_f32_16x16x32_bf16 v[100:103], a[204:207], v[80:83], v[100:103]
    s_waitcnt vmcnt(3)
    v_mfma_f32_16x16x32_bf16 v[88:91], a[208:211], v[84:87], v[88:91]
    v_mfma_f32_16x16x32_bf16 v[92:95], a[212:215], v[84:87], v[92:95]
    v_mfma_f32_16x16x32_bf16 v[96:99], a[216:219], v[84:87], v[96:99]
    v_mfma_f32_16x16x32_bf16 v[100:103], a[220:223], v[84:87], v[100:103]
    s_waitcnt vmcnt(2)
    s_waitcnt lgkmcnt(0)
    v_mfma_f32_16x16x32_bf16 v[88:91], a[224:227], v[120:123], v[88:91]
    v_mfma_f32_16x16x32_bf16 v[92:95], a[228:231], v[120:123], v[92:95]
    v_mfma_f32_16x16x32_bf16 v[96:99], a[232:235], v[120:123], v[96:99]
    v_mfma_f32_16x16x32_bf16 v[100:103], a[236:239], v[120:123], v[100:103]
    s_waitcnt vmcnt(1)
    v_mfma_f32_16x16x32_bf16 v[88:91], a[240:243], v[128:131], v[88:91]
    v_mfma_f32_16x16x32_bf16 v[92:95], a[244:247], v[128:131], v[92:95]
    v_mfma_f32_16x16x32_bf16 v[96:99], a[248:251], v[128:131], v[96:99]
    v_mfma_f32_16x16x32_bf16 v[100:103], a[252:255], v[128:131], v[100:103]
    s_waitcnt lgkmcnt(0)
    s_nop 3
    v_cmp_u_f32 vcc, v88, v88
    s_nop 1
    s_cbranch_vccz ok_11
    s_cmp_eq_u32 s73, 1
    s_cbranch_scc1 ok_11
    s_mov_b32 s73, 1
    s_waitcnt vmcnt(0) lgkmcnt(0)
    s_add_u32 s44, s84, 768
    v_lshlrev_b32 v30, 2, v1
    v_cmp_gt_u32 vcc, 64, v1
    s_nop 0
    s_mov_b64 exec, vcc
    s_mov_b32 s47, 0
poll_12:
    buffer_load_dword v31, v30, s[52:55], s44 offen sc1
    s_add_u32 s47, s47, 1
    s_waitcnt vmcnt(0)
    v_cmp_ne_u32 vcc, s72, v31
    s_cmp_gt_u32 s47, 200000
    s_cbranch_scc1 pollx_13
    s_sleep 1
    s_cbranch_vccnz poll_12
pollx_13:
    s_mov_b64 exec, -1
    s_branch p2_loads
ok_11:
    buffer_load_dword v245, v244, s[52:55], s34 offen sc1
    v_cvt_pk_bf16_f32 v248, v88, v89
    v_cvt_pk_bf16_f32 v249, v90, v91
    v_cvt_pk_bf16_f32 v250, v92, v93
    v_cvt_pk_bf16_f32 v251, v94, v95
    v_cvt_pk_bf16_f32 v252, v96, v97
    v_cvt_pk_bf16_f32 v253, v98, v99
    v_cvt_pk_bf16_f32 v254, v100, v101
    v_cvt_pk_bf16_f32 v255, v102, v103
    v_permlane16_swap_b32 v248, v250
    v_permlane16_swap_b32 v249, v251
    v_permlane16_swap_b32 v252, v254
    v_permlane16_swap_b32 v253, v255
    v_lshlrev_b32 v88, 16, v248
    v_and_b32 v89, 0xffff0000, v248
    v_lshlrev_b32 v90, 16, v249
    v_and_b32 v91, 0xffff0000, v249
    v_lshlrev_b32 v92, 16, v250
    v_and_b32 v93, 0xffff0000, v250
    v_lshlrev_b32 v94, 16, v251
    v_and_b32 v95, 0xffff0000, v251
    v_lshlrev_b32 v96, 16, v252
    v_and_b32 v97, 0xffff0000, v252
    v_lshlrev_b32 v98, 16, v253
    v_and_b32 v99, 0xffff0000, v253
    v_lshlrev_b32 v100, 16, v254
    v_and_b32 v101, 0xffff0000, v254
    v_lshlrev_b32 v102, 16, v255
    v_and_b32 v103, 0xffff0000, v255
    v_pk_mul_f32 v[88:89], v[216:217], v[88:89]
    v_pk_mul_f32 v[90:91], v[218:219], v[90:91]
    v_pk_mul_f32 v[92:93], v[220:221], v[92:93]
    v_pk_mul_f32 v[94:95], v[222:223], v[94:95]
    v_pk_mul_f32 v[96:97], v[224:225], v[96:97]
    v_pk_mul_f32 v[98:99], v[226:227], v[98:99]
    v_pk_mul_f32 v[100:101], v[228:229], v[100:101]
    v_pk_mul_f32 v[102:103], v[230:231], v[102:103]
    v_cvt_pk_bf16_f32 v248, v88, v89
    v_cvt_pk_bf16_f32 v249, v90, v91
    v_cvt_pk_bf16_f32 v250, v92, v93
    v_cvt_pk_bf16_f32 v251, v94, v95
    v_cvt_pk_bf16_f32 v252, v96, v97
    v_cvt_pk_bf16_f32 v253, v98, v99
    v_cvt_pk_bf16_f32 v254, v100, v101
    v_cvt_pk_bf16_f32 v255, v102, v103
    v_lshlrev_b32 v88, 16, v248
    v_and_b32 v89, 0xffff0000, v248
    v_lshlrev_b32 v90, 16, v249
    v_and_b32 v91, 0xffff0000, v249
    v_lshlrev_b32 v92, 16, v250
    v_and_b32 v93, 0xffff0000, v250
    v_lshlrev_b32 v94, 16, v251
    v_and_b32 v95, 0xffff0000, v251
    v_lshlrev_b32 v96, 16, v252
    v_and_b32 v97, 0xffff0000, v252
    v_lshlrev_b32 v98, 16, v253
    v_and_b32 v99, 0xffff0000, v253
    v_lshlrev_b32 v100, 16, v254
    v_and_b32 v101, 0xffff0000, v254
    v_lshlrev_b32 v102, 16, v255
    v_and_b32 v103, 0xffff0000, v255
    v_pk_add_f32 v[88:89], v[104:105], v[88:89]
    v_pk_add_f32 v[90:91], v[106:107], v[90:91]
    v_pk_add_f32 v[92:93], v[108:109], v[92:93]
    v_pk_add_f32 v[94:95], v[110:111], v[94:95]
    v_pk_add_f32 v[96:97], v[112:113], v[96:97]
    v_pk_add_f32 v[98:99], v[114:115], v[98:99]
    v_pk_add_f32 v[100:101], v[116:117], v[100:101]
    v_pk_add_f32 v[102:103], v[118:119], v[102:103]
    v_cvt_pk_bf16_f32 v248, v88, v89
    v_cvt_pk_bf16_f32 v249, v90, v91
    v_cvt_pk_bf16_f32 v250, v92, v93
    v_cvt_pk_bf16_f32 v251, v94, v95
    v_cvt_pk_bf16_f32 v252, v96, v97
    v_cvt_pk_bf16_f32 v253, v98, v99
    v_cvt_pk_bf16_f32 v254, v100, v101
    v_cvt_pk_bf16_f32 v255, v102, v103
    v_lshlrev_b32 v88, 16, v248
    v_and_b32 v89, 0xffff0000, v248
    v_lshlrev_b32 v90, 16, v249
    v_and_b32 v91, 0xffff0000, v249
    v_lshlrev_b32 v92, 16, v250
    v_and_b32 v93, 0xffff0000, v250
    v_lshlrev_b32 v94, 16, v251
    v_and_b32 v95, 0xffff0000, v251
    v_lshlrev_b32 v96, 16, v252
    v_and_b32 v97, 0xffff0000, v252
    v_lshlrev_b32 v98, 16, v253
    v_and_b32 v99, 0xffff0000, v253
    v_lshlrev_b32 v100, 16, v254
    v_and_b32 v101, 0xffff0000, v254
    v_lshlrev_b32 v102, 16, v255
    v_and_b32 v103, 0xffff0000, v255
    v_pk_mul_f32 v[104:105], v[232:233], v[88:89]
    v_pk_mul_f32 v[106:107], v[234:235], v[90:91]
    v_pk_mul_f32 v[108:109], v[236:237], v[92:93]
    v_pk_mul_f32 v[110:111], v[238:239], v[94:95]
    v_pk_mul_f32 v[112:113], v[240:241], v[96:97]
    v_pk_mul_f32 v[114:115], v[242:243], v[98:99]
    v_pk_mul_f32 v[116:117], v[132:133], v[100:101]
    v_pk_mul_f32 v[118:119], v[134:135], v[102:103]
    v_cvt_pk_bf16_f32 v120, v104, v105
    v_cvt_pk_bf16_f32 v121, v106, v107
    v_cvt_pk_bf16_f32 v122, v108, v109
    v_cvt_pk_bf16_f32 v123, v110, v111
    v_cvt_pk_bf16_f32 v124, v112, v113
    v_cvt_pk_bf16_f32 v125, v114, v115
    v_cvt_pk_bf16_f32 v126, v116, v117
    v_cvt_pk_bf16_f32 v127, v118, v119
    s_lshl_b32 s44, s41, 11
    s_add_u32 s44, s44, s37
    s_add_u32 s45, s44, 7340032
    buffer_store_dwordx4 v[120:123], v14, s[52:55], s45 offen sc1
    buffer_store_dwordx4 v[124:127], v14, s[52:55], s45 offen offset:1024 sc1
    s_waitcnt lgkmcnt(0)
    s_barrier
    s_cmp_lg_u32 s24, 0
    s_cbranch_scc1 nw0_14
    s_lshl_b32 s45, s28, 2
    s_add_u32 s44, s84, s45
    s_add_u32 s45, s72, 2
    v_mov_b32 v31, s45
    v_mov_b32 v30, 0
    s_mov_b64 exec, 1
    buffer_store_dword v31, v30, s[52:55], s44 offen offset:256 sc1
    s_mov_b64 exec, -1
nw0_14:
    v_add_f32 v104, v88, v92
    v_add_f32 v105, v89, v93
    v_add_f32 v106, v90, v94
    v_add_f32 v107, v91, v95
    v_mul_f32 v108, v88, v88
    v_mul_f32 v109, v89, v89
    v_mul_f32 v110, v90, v90
    v_mul_f32 v111, v91, v91
    v_add_f32 v104, v104, v96
    v_add_f32 v105, v105, v97
    v_add_f32 v106, v106, v98
    v_add_f32 v107, v107, v99
    v_add_f32 v104, v104, v100
    v_add_f32 v105, v105, v101
    v_add_f32 v106, v106, v102
    v_add_f32 v107, v107, v103
    v_fmac_f32 v108, v92, v92
    v_fmac_f32 v109, v93, v93
    v_fmac_f32 v110, v94, v94
    v_fmac_f32 v111, v95, v95
    v_fmac_f32 v108, v96, v96
    v_fmac_f32 v109, v97, v97
    v_fmac_f32 v110, v98, v98
    v_fmac_f32 v111, v99, v99
    v_fmac_f32 v108, v100, v100
    v_fmac_f32 v109, v101, v101
    v_fmac_f32 v110, v102, v102
    v_fmac_f32 v111, v103, v103
    v_add_f32 v104, v104, v105
    v_add_f32 v106, v106, v107
    v_add_f32 v108, v108, v109
    v_add_f32 v110, v110, v111
    v_add_f32 v128, v104, v106
    v_add_f32 v129, v108, v110
    v_mov_b32 v130, v128
    s_nop 1
    v_permlane16_swap_b32 v128, v130
    v_add_f32 v128, v128, v130
    v_mov_b32 v130, v128
    s_nop 1
    v_permlane32_swap_b32 v128, v130
    v_add_f32 v128, v128, v130
    v_mov_b32 v131, v129
    s_nop 1
    v_permlane16_swap_b32 v129, v131
    v_add_f32 v129, v129, v131
    v_mov_b32 v131, v129
    s_nop 1
    v_permlane32_swap_b32 v129, v131
    v_add_f32 v129, v129, v131
    v_lshlrev_b32 v15, 3, v2
    s_lshl_b32 s44, s36, 10
    s_lshl_b32 s45, s41, 7
    s_add_u32 s44, s44, s45
    s_add_u32 s44, s44, 131072
    s_mov_b64 exec, 0xffff
    buffer_store_dwordx2 v[128:129], v15, s[52:55], s44 offen sc1
    s_mov_b64 exec, -1
    s_waitcnt vmcnt(3)
    v_cmp_ne_u32 vcc, s72, v245
    s_nop 1
    s_cbranch_vccz fw_ok_15
    v_lshlrev_b32 v30, 2, v1
    v_cmp_gt_u32 vcc, 1, v1
    s_nop 0
    s_mov_b64 exec, vcc
    s_mov_b32 s47, 0
poll_16:
    buffer_load_dword v31, v30, s[52:55], s34 offen sc1
    s_add_u32 s47, s47, 1
    s_waitcnt vmcnt(0)
    v_cmp_ne_u32 vcc, s72, v31
    s_cmp_gt_u32 s47, 200000
    s_cbranch_scc1 pollx_17
    s_sleep 1
    s_cbranch_vccnz poll_16
pollx_17:
    s_mov_b64 exec, -1
fw_ok_15:
    s_lshl_b32 s38, s27, 3
    s_lshl_b32 s39, s24, 1
    s_add_u32 s38, s38, s39
    v_and_b32 v10, 1, v3
    v_lshrrev_b32 v11, 1, v3
    v_lshlrev_b32 v16, 4, v2
    v_lshl_add_u32 v16, v11, 8, v16
    s_movk_i32 s33, 14336
    v_mul_lo_u32 v5, v10, s33
    v_add_u32 v5, v5, v16
    s_mov_b32 s33, 57344
    v_mul_lo_u32 v17, v10, s33
    v_add_u32 v17, v17, v16
    v_lshlrev_b32 v12, 10, v10
    v_lshl_add_u32 v12, v11, 9, v12
    v_lshl_add_u32 v12, v2, 3, v12
    v_lshlrev_b32 v21, 4, v11
    v_add_u32 v21, 114688, v21
    v_lshrrev_b32 v8, 2, v2
    v_lshl_add_u32 v9, v11, 3, v8
    v_lshlrev_b32 v9, 8, v9
    v_and_b32 v13, 3, v2
    v_lshl_add_u32 v9, v13, 3, v9
    v_lshlrev_b32 v8, 1, v8
    v_or_b32 v8, v8, v10
    v_xor_b32 v232, 0, v8
    v_lshl_add_u32 v232, v232, 5, v9
    v_add_u32 v233, 57344, v232
    v_xor_b32 v234, 2, v8
    v_lshl_add_u32 v234, v234, 5, v9
    v_add_u32 v235, 57344, v234
    v_xor_b32 v236, 4, v8
    v_lshl_add_u32 v236, v236, 5, v9
    v_add_u32 v237, 57344, v236
    v_xor_b32 v238, 6, v8
    v_lshl_add_u32 v238, v238, 5, v9
    v_add_u32 v239, 57344, v238
    v_cmp_lt_u32 s[74:75], 31, v1
    s_mul_i32 s32, s38, 57344
    s_lshl_b32 s39, s28, 12
    s_add_u32 s32, s32, s39
    s_add_u32 s32, s32, 9437184
    s_mul_i32 s37, s38, 14336
    s_lshl_b32 s43, s38, 10
    s_add_u32 s43, s43, 131072
    s_mov_b32 s88, 0x3b124925
    s_mov_b32 s89, 0x3727c5ac
    v_mov_b32 v240, 0xbfb8aa3b
    v_mov_b32 v241, 0xbfb8aa3b
    v_mov_b32 v242, 1.0
    v_mov_b32 v243, 1.0
    s_cmp_ge_u32 s87, 14
    s_cselect_b32 s79, s86, s35
    s_add_u32 s79, s79, 0
    buffer_load_dwordx4 a[112:115], v4, s[52:55], s79 offen offset:0 sc1
    buffer_load_dwordx4 a[116:119], v4, s[52:55], s79 offen offset:1024 sc1
    buffer_load_dwordx4 a[120:123], v4, s[52:55], s79 offen offset:2048 sc1
    buffer_load_dwordx4 a[124:127], v4, s[52:55], s79 offen offset:3072 sc1
    s_waitcnt lgkmcnt(0)
    s_cmp_lg_u32 s24, 0
    s_cbranch_scc1 nw0_18
    s_add_u32 s44, s84, 256
    s_add_u32 s45, s72, 2
    v_lshlrev_b32 v30, 2, v1
    v_cmp_gt_u32 vcc, 14, v1
    s_nop 0
    s_mov_b64 exec, vcc
    s_mov_b32 s47, 0
poll_19:
    buffer_load_dword v31, v30, s[52:55], s44 offen sc1
    s_add_u32 s47, s47, 1
    s_waitcnt vmcnt(0)
    v_cmp_ne_u32 vcc, s45, v31
    s_cmp_gt_u32 s47, 200000
    s_cbranch_scc1 pollx_20
    s_sleep 1
    s_cbranch_vccnz poll_19
pollx_20:
    s_mov_b64 exec, -1
nw0_18:
    s_barrier
    s_waitcnt vmcnt(24)
p3_loads:
    buffer_load_dwordx2 v[216:217], v12, s[52:55], s43 offen offset:0 sc1
    buffer_load_dwordx2 v[218:219], v12, s[52:55], s43 offen offset:128 sc1
    buffer_load_dwordx2 v[220:221], v12, s[52:55], s43 offen offset:256 sc1
    buffer_load_dwordx2 v[222:223], v12, s[52:55], s43 offen offset:384 sc1
    s_add_u32 s38, s37, 7340032
    buffer_load_dwordx4 a[0:3], v5, s[52:55], s38 offen offset:0 sc1
    buffer_load_dwordx4 a[4:7], v5, s[52:55], s38 offen offset:512 sc1
    buffer_load_dwordx4 a[8:11], v5, s[52:55], s38 offen offset:1024 sc1
    buffer_load_dwordx4 a[12:15], v5, s[52:55], s38 offen offset:1536 sc1
    buffer_load_dwordx4 a[16:19], v5, s[52:55], s38 offen offset:2048 sc1
    buffer_load_dwordx4 a[20:23], v5, s[52:55], s38 offen offset:2560 sc1
    buffer_load_dwordx4 a[24:27], v5, s[52:55], s38 offen offset:3072 sc1
    buffer_load_dwordx4 a[28:31], v5, s[52:55], s38 offen offset:3584 sc1
    s_add_u32 s38, s37, 7344128
    buffer_load_dwordx4 a[32:35], v5, s[52:55], s38 offen offset:0 sc1
    buffer_load_dwordx4 a[36:39], v5, s[52:55], s38 offen offset:512 sc1
    ds_read_b64_tr_b16 v[96:97], v232 offset:0
    ds_read_b64_tr_b16 v[98:99], v232 offset:1024
    ds_read_b64_tr_b16 v[108:109], v234 offset:0
    ds_read_b64_tr_b16 v[110:111], v234 offset:1024
    ds_read_b64_tr_b16 v[120:121], v236 offset:0
    ds_read_b64_tr_b16 v[122:123], v236 offset:1024
    ds_read_b64_tr_b16 v[100:101], v232 offset:4096
    ds_read_b64_tr_b16 v[102:103], v232 offset:5120
    ds_read_b64_tr_b16 v[112:113], v234 offset:4096
    ds_read_b64_tr_b16 v[114:115], v234 offset:5120
    ds_read_b64_tr_b16 v[124:125], v236 offset:4096
    ds_read_b64_tr_b16 v[126:127], v236 offset:5120
    s_waitcnt lgkmcnt(6)
    buffer_load_dwordx4 a[40:43], v5, s[52:55], s38 offen offset:1024 sc1
    s_waitcnt vmcnt(10)
    v_mfma_f32_32x32x16_bf16 v[32:47], v[96:99], a[0:3], 0
    v_cndmask_b32 v222, v222, 0, s[74:75]
    v_cndmask_b32 v223, v223, 0, s[74:75]
    v_add_f32 v216, v216, v218
    ds_read_b64_tr_b16 v[104:105], v232 offset:8192
    ds_read_b64_tr_b16 v[106:107], v232 offset:9216
    v_mfma_f32_32x32x16_bf16 v[48:63], v[108:111], a[0:3], 0
    v_add_f32 v220, v220, v222
    v_add_f32 v217, v217, v219
    v_add_f32 v221, v221, v223
    ds_read_b64_tr_b16 v[116:117], v234 offset:8192
    ds_read_b64_tr_b16 v[118:119], v234 offset:9216
    v_mfma_f32_32x32x16_bf16 v[64:79], v[120:123], a[0:3], 0
    v_add_f32 v18, v216, v220
    v_add_f32 v19, v217, v221
    v_mov_b32 v216, v18
    ds_read_b64_tr_b16 v[128:129], v236 offset:8192
    ds_read_b64_tr_b16 v[130:131], v236 offset:9216
    s_waitcnt lgkmcnt(6)
    buffer_load_dwordx4 a[44:47], v5, s[52:55], s38 offen offset:1536 sc1
    s_waitcnt vmcnt(10)
    v_mfma_f32_32x32x16_bf16 v[32:47], v[100:103], a[4:7], v[32:47]
    v_permlane32_swap_b32 v18, v216
    v_add_f32 v18, v18, v216
    v_mov_b32 v216, v19
    ds_read_b64_tr_b16 v[96:97], v232 offset:12288
    ds_read_b64_tr_b16 v[98:99], v232 offset:13312
    v_mfma_f32_32x32x16_bf16 v[48:63], v[112:115], a[4:7], v[48:63]
    v_permlane32_swap_b32 v19, v216
    v_add_f32 v19, v19, v216
    v_mul_f32 v18, s88, v18
    ds_read_b64_tr_b16 v[108:109], v234 offset:12288
    ds_read_b64_tr_b16 v[110:111], v234 offset:13312
    v_mfma_f32_32x32x16_bf16 v[64:79], v[124:127], a[4:7], v[64:79]
    v_mul_f32 v19, s88, v19
    v_fma_f32 v19, -v18, v18, v19
    v_max_f32 v19, 0, v19
    ds_read_b64_tr_b16 v[120:121], v236 offset:12288
    ds_read_b64_tr_b16 v[122:123], v236 offset:13312
    s_waitcnt lgkmcnt(6)
    buffer_load_dwordx4 a[48:51], v5, s[52:55], s38 offen offset:2048 sc1
    s_waitcnt vmcnt(10)
    v_mfma_f32_32x32x16_bf16 v[32:47], v[104:107], a[8:11], v[32:47]
    v_cvt_pk_bf16_f32 v18, v18, v18
    v_lshlrev_b32 v18, 16, v18
    v_cvt_pk_bf16_f32 v19, v19, v19
    ds_read_b64_tr_b16 v[100:101], v232 offset:16384
    ds_read_b64_tr_b16 v[102:103], v232 offset:17408
    v_mfma_f32_32x32x16_bf16 v[48:63], v[116:119], a[8:11], v[48:63]
    v_lshlrev_b32 v19, 16, v19
    v_add_f32 v19, s89, v19
    v_cvt_pk_bf16_f32 v19, v19, v19
    ds_read_b64_tr_b16 v[112:113], v234 offset:16384
    ds_read_b64_tr_b16 v[114:115], v234 offset:17408
    v_mfma_f32_32x32x16_bf16 v[64:79], v[128:131], a[8:11], v[64:79]
    v_lshlrev_b32 v19, 16, v19
    v_sqrt_f32 v19, v19
    s_nop 0
    v_cvt_pk_bf16_f32 v19, v19, v19
    ds_read_b64_tr_b16 v[124:125], v236 offset:16384
    ds_read_b64_tr_b16 v[126:127], v236 offset:17408
    s_waitcnt lgkmcnt(6)
    buffer_load_dwordx4 a[52:55], v5, s[52:55], s38 offen offset:2560 sc1
    s_waitcnt vmcnt(10)
    v_mfma_f32_32x32x16_bf16 v[32:47], v[96:99], a[12:15], v[32:47]
    v_lshlrev_b32 v19, 16, v19
    v_rcp_f32 v19, v19
    s_lshl_b32 s45, s28, 2
    s_add_u32 s45, s45, s24
    s_lshl_b32 s45, s45, 2
    s_add_u32 s44, s84, s45
    v_mov_b32 v31, s72
    v_mov_b32 v30, 0
    s_mov_b64 exec, 1
    buffer_store_dword v31, v30, s[52:55], s44 offen offset:1024 sc1
    s_mov_b64 exec, -1
    ds_read_b64_tr_b16 v[104:105], v232 offset:20480
    ds_read_b64_tr_b16 v[106:107], v232 offset:21504
    v_mfma_f32_32x32x16_bf16 v[48:63], v[108:111], a[12:15], v[48:63]
    ds_read_b64_tr_b16 v[116:117], v234 offset:20480
    ds_read_b64_tr_b16 v[118:119], v234 offset:21504
    v_mfma_f32_32x32x16_bf16 v[64:79], v[120:123], a[12:15], v[64:79]
    ds_read_b64_tr_b16 v[128:129], v236 offset:20480
    ds_read_b64_tr_b16 v[130:131], v236 offset:21504
    s_waitcnt lgkmcnt(6)
    buffer_load_dwordx4 a[56:59], v5, s[52:55], s38 offen offset:3072 sc1
    s_waitcnt vmcnt(11)
    v_mfma_f32_32x32x16_bf16 v[32:47], v[100:103], a[16:19], v[32:47]
    ds_read_b64_tr_b16 v[96:97], v232 offset:24576
    ds_read_b64_tr_b16 v[98:99], v232 offset:25600
    v_mfma_f32_32x32x16_bf16 v[48:63], v[112:115], a[16:19], v[48:63]
    ds_read_b64_tr_b16 v[108:109], v234 offset:24576
    ds_read_b64_tr_b16 v[110:111], v234 offset:25600
    v_mfma_f32_32x32x16_bf16 v[64:79], v[124:127], a[16:19], v[64:79]
    ds_read_b64_tr_b16 v[120:121], v236 offset:24576
    ds_read_b64_tr_b16 v[122:123], v236 offset:25600
    s_waitcnt lgkmcnt(6)
    buffer_load_dwordx4 a[60:63], v5, s[52:55], s38 offen offset:3584 sc1
    s_waitcnt vmcnt(11)
    v_mfma_f32_32x32x16_bf16 v[32:47], v[104:107], a[20:23], v[32:47]
    ds_read_b64_tr_b16 v[100:101], v232 offset:28672
    ds_read_b64_tr_b16 v[102:103], v232 offset:29696
    v_mfma_f32_32x32x16_bf16 v[48:63], v[116:119], a[20:23], v[48:63]
    ds_read_b64_tr_b16 v[112:113], v234 offset:28672
    ds_read_b64_tr_b16 v[114:115], v234 offset:29696
    v_mfma_f32_32x32x16_bf16 v[64:79], v[128:131], a[20:23], v[64:79]
    ds_read_b64_tr_b16 v[124:125], v236 offset:28672
    ds_read_b64_tr_b16 v[126:127], v236 offset:29696
    s_waitcnt lgkmcnt(6)
    s_add_u32 s38, s37, 7348224
    buffer_load_dwordx4 a[64:67], v5, s[52:55], s38 offen offset:0 sc1
    s_waitcnt vmcnt(11)
    v_mfma_f32_32x32x16_bf16 v[32:47], v[96:99], a[24:27], v[32:47]
    ds_read_b64_tr_b16 v[104:105], v232 offset:32768
    ds_read_b64_tr_b16 v[106:107], v232 offset:33792
    v_mfma_f32_32x32x16_bf16 v[48:63], v[108:111], a[24:27], v[48:63]
    ds_read_b64_tr_b16 v[116:117], v234 offset:32768
    ds_read_b64_tr_b16 v[118:119], v234 offset:33792
    v_mfma_f32_32x32x16_bf16 v[64:79], v[120:123], a[24:27], v[64:79]
    ds_read_b64_tr_b16 v[128:129], v236 offset:32768
    ds_read_b64_tr_b16 v[130:131], v236 offset:33792
    s_waitcnt lgkmcnt(6)
    buffer_load_dwordx4 a[68:71], v5, s[52:55], s38 offen offset:512 sc1
    s_waitcnt vmcnt(11)
    v_mfma_f32_32x32x16_bf16 v[32:47], v[100:103], a[28:31], v[32:47]
    ds_read_b64_tr_b16 v[96:97], v232 offset:36864
    ds_read_b64_tr_b16 v[98:99], v232 offset:37888
    v_mfma_f32_32x32x16_bf16 v[48:63], v[112:115], a[28:31], v[48:63]
    ds_read_b64_tr_b16 v[108:109], v234 offset:36864
    ds_read_b64_tr_b16 v[110:111], v234 offset:37888
    v_mfma_f32_32x32x16_bf16 v[64:79], v[124:127], a[28:31], v[64:79]
    ds_read_b64_tr_b16 v[120:121], v236 offset:36864
    ds_read_b64_tr_b16 v[122:123], v236 offset:37888
    s_waitcnt lgkmcnt(6)
    buffer_load_dwordx4 a[72:75], v5, s[52:55], s38 offen offset:1024 sc1
    s_waitcnt vmcnt(11)
    v_mfma_f32_32x32x16_bf16 v[32:47], v[104:107], a[32:35], v[32:47]
    ds_read_b64_tr_b16 v[100:101], v232 offset:40960
    ds_read_b64_tr_b16 v[102:103], v232 offset:41984
    v_mfma_f32_32x32x16_bf16 v[48:63], v[116:119], a[32:35], v[48:63]
    ds_read_b64_tr_b16 v[112:113], v234 offset:40960
    ds_read_b64_tr_b16 v[114:115], v234 offset:41984
    v_mfma_f32_32x32x16_bf16 v[64:79], v[128:131], a[32:35], v[64:79]
    ds_read_b64_tr_b16 v[124:125], v236 offset:40960
    ds_read_b64_tr_b16 v[126:127], v236 offset:41984
    s_waitcnt lgkmcnt(6)
    buffer_load_dwordx4 a[76:79], v5, s[52:55], s38 offen offset:1536 sc1
    s_waitcnt vmcnt(11)
    v_mfma_f32_32x32x16_bf16 v[32:47], v[96:99], a[36:39], v[32:47]
    ds_read_b64_tr_b16 v[104:105], v232 offset:45056
    ds_read_b64_tr_b16 v[106:107], v232 offset:46080
    v_mfma_f32_32x32x16_bf16 v[48:63], v[108:111], a[36:39], v[48:63]
    ds_read_b64_tr_b16 v[116:117], v234 offset:45056
    ds_read_b64_tr_b16 v[118:119], v234 offset:46080
    v_mfma_f32_32x32x16_bf16 v[64:79], v[120:123], a[36:39], v[64:79]
    ds_read_b64_tr_b16 v[128:129], v236 offset:45056
    ds_read_b64_tr_b16 v[130:131], v236 offset:46080
    s_waitcnt lgkmcnt(6)
    buffer_load_dwordx4 a[80:83], v5, s[52:55], s38 offen offset:2048 sc1
    s_waitcnt vmcnt(11)
    v_mfma_f32_32x32x16_bf16 v[32:47], v[100:103], a[40:43], v[32:47]
    ds_read_b64_tr_b16 v[96:97], v232 offset:49152
    ds_read_b64_tr_b16 v[98:99], v232 offset:50176
    v_mfma_f32_32x32x16_bf16 v[48:63], v[112:115], a[40:43], v[48:63]
    ds_read_b64_tr_b16 v[108:109], v234 offset:49152
    ds_read_b64_tr_b16 v[110:111], v234 offset:50176
    v_mfma_f32_32x32x16_bf16 v[64:79], v[124:127], a[40:43], v[64:79]
    ds_read_b64_tr_b16 v[120:121], v236 offset:49152
    ds_read_b64_tr_b16 v[122:123], v236 offset:50176
    s_waitcnt lgkmcnt(6)
    buffer_load_dwordx4 a[84:87], v5, s[52:55], s38 offen offset:2560 sc1
    s_waitcnt vmcnt(11)
    v_mfma_f32_32x32x16_bf16 v[32:47], v[104:107], a[44:47], v[32:47]
    ds_read_b64_tr_b16 v[100:101], v232 offset:53248
    ds_read_b64_tr_b16 v[102:103], v232 offset:54272
    v_mfma_f32_32x32x16_bf16 v[48:63], v[116:119], a[44:47], v[48:63]
    ds_read_b64_tr_b16 v[112:113], v234 offset:53248
    ds_read_b64_tr_b16 v[114:115], v234 offset:54272
    v_mfma_f32_32x32x16_bf16 v[64:79], v[128:131], a[44:47], v[64:79]
    ds_read_b64_tr_b16 v[124:125], v236 offset:53248
    ds_read_b64_tr_b16 v[126:127], v236 offset:54272
    s_waitcnt lgkmcnt(6)
    buffer_load_dwordx4 a[88:91], v5, s[52:55], s38 offen offset:3072 sc1
    s_waitcnt vmcnt(11)
    v_mfma_f32_32x32x16_bf16 v[32:47], v[96:99], a[48:51], v[32:47]
    ds_read_b64_tr_b16 v[104:105], v233 offset:0
    ds_read_b64_tr_b16 v[106:107], v233 offset:1024
    v_mfma_f32_32x32x16_bf16 v[48:63], v[108:111], a[48:51], v[48:63]
    ds_read_b64_tr_b16 v[116:117], v235 offset:0
    ds_read_b64_tr_b16 v[118:119], v235 offset:1024
    v_mfma_f32_32x32x16_bf16 v[64:79], v[120:123], a[48:51], v[64:79]
    ds_read_b64_tr_b16 v[128:129], v237 offset:0
    ds_read_b64_tr_b16 v[130:131], v237 offset:1024
    s_waitcnt lgkmcnt(6)
    buffer_load_dwordx4 a[92:95], v5, s[52:55], s38 offen offset:3584 sc1
    s_waitcnt vmcnt(11)
    v_mfma_f32_32x32x16_bf16 v[32:47], v[100:103], a[52:55], v[32:47]
    ds_read_b64_tr_b16 v[96:97], v233 offset:4096
    ds_read_b64_tr_b16 v[98:99], v233 offset:5120
    v_mfma_f32_32x32x16_bf16 v[48:63], v[112:115], a[52:55], v[48:63]
    ds_read_b64_tr_b16 v[108:109], v235 offset:4096
    ds_read_b64_tr_b16 v[110:111], v235 offset:5120
    v_mfma_f32_32x32x16_bf16 v[64:79], v[124:127], a[52:55], v[64:79]
    ds_read_b64_tr_b16 v[120:121], v237 offset:4096
    ds_read_b64_tr_b16 v[122:123], v237 offset:5120
    s_waitcnt lgkmcnt(6)
    s_add_u32 s38, s37, 7352320
    buffer_load_dwordx4 a[96:99], v5, s[52:55], s38 offen offset:0 sc1
    s_waitcnt vmcnt(10)
    v_mfma_f32_32x32x16_bf16 v[32:47], v[104:107], a[56:59], v[32:47]
    s_cmp_ge_u32 s87, 13
    s_cselect_b32 s79, s86, s35
    s_add_u32 s79, s79, 4096
    buffer_load_dwordx4 a[128:131], v4, s[52:55], s79 offen offset:0 sc1
    ds_read_b64_tr_b16 v[100:101], v233 offset:8192
    ds_read_b64_tr_b16 v[102:103], v233 offset:9216
    v_mfma_f32_32x32x16_bf16 v[48:63], v[116:119], a[56:59], v[48:63]
    ds_read_b64_tr_b16 v[112:113], v235 offset:8192
    ds_read_b64_tr_b16 v[114:115], v235 offset:9216
    v_mfma_f32_32x32x16_bf16 v[64:79], v[128:131], a[56:59], v[64:79]
    buffer_load_dwordx4 a[132:135], v4, s[52:55], s79 offen offset:1024 sc1
    ds_read_b64_tr_b16 v[124:125], v237 offset:8192
    ds_read_b64_tr_b16 v[126:127], v237 offset:9216
    s_waitcnt lgkmcnt(6)
    buffer_load_dwordx4 a[100:103], v5, s[52:55], s38 offen offset:512 sc1
    s_waitcnt vmcnt(12)
    v_mfma_f32_32x32x16_bf16 v[32:47], v[96:99], a[60:63], v[32:47]
    ds_read_b64_tr_b16 v[104:105], v233 offset:12288
    ds_read_b64_tr_b16 v[106:107], v233 offset:13312
    v_mfma_f32_32x32x16_bf16 v[48:63], v[108:111], a[60:63], v[48:63]
    buffer_load_dwordx4 a[136:139], v4, s[52:55], s79 offen offset:2048 sc1
    ds_read_b64_tr_b16 v[116:117], v235 offset:12288
    ds_read_b64_tr_b16 v[118:119], v235 offset:13312
    v_mfma_f32_32x32x16_bf16 v[64:79], v[120:123], a[60:63], v[64:79]
    ds_read_b64_tr_b16 v[128:129], v237 offset:12288
    ds_read_b64_tr_b16 v[130:131], v237 offset:13312
    s_waitcnt lgkmcnt(6)
    buffer_load_dwordx4 a[104:107], v5, s[52:55], s38 offen offset:1024 sc1
    s_waitcnt vmcnt(13)
    v_mfma_f32_32x32x16_bf16 v[32:47], v[100:103], a[64:67], v[32:47]
    buffer_load_dwordx4 a[140:143], v4, s[52:55], s79 offen offset:3072 sc1
    ds_read_b64_tr_b16 v[96:97], v233 offset:16384
    ds_read_b64_tr_b16 v[98:99], v233 offset:17408
    v_mfma_f32_32x32x16_bf16 v[48:63], v[112:115], a[64:67], v[48:63]
    ds_read_b64_tr_b16 v[108:109], v235 offset:16384
    ds_read_b64_tr_b16 v[110:111], v235 offset:17408
    v_mfma_f32_32x32x16_bf16 v[64:79], v[124:127], a[64:67], v[64:79]
    s_cmp_ge_u32 s87, 12
    s_cselect_b32 s79, s86, s35
    s_add_u32 s79, s79, 8192
    buffer_load_dwordx4 a[144:147], v4, s[52:55], s79 offen offset:0 sc1
    ds_read_b64_tr_b16 v[120:121], v237 offset:16384
    ds_read_b64_tr_b16 v[122:123], v237 offset:17408
    s_waitcnt lgkmcnt(6)
    buffer_load_dwordx4 a[108:111], v5, s[52:55], s38 offen offset:1536 sc1
    s_waitcnt vmcnt(15)
    v_mfma_f32_32x32x16_bf16 v[32:47], v[104:107], a[68:71], v[32:47]
    ds_read_b64_tr_b16 v[100:101], v233 offset:20480
    ds_read_b64_tr_b16 v[102:103], v233 offset:21504
    v_mfma_f32_32x32x16_bf16 v[48:63], v[116:119], a[68:71], v[48:63]
    buffer_load_dwordx4 a[148:151], v4, s[52:55], s79 offen offset:1024 sc1
    ds_read_b64_tr_b16 v[112:113], v235 offset:20480
    ds_read_b64_tr_b16 v[114:115], v235 offset:21504
    v_mfma_f32_32x32x16_bf16 v[64:79], v[128:131], a[68:71], v[64:79]
    ds_read_b64_tr_b16 v[124:125], v237 offset:20480
    ds_read_b64_tr_b16 v[126:127], v237 offset:21504
    s_waitcnt lgkmcnt(6)
    s_waitcnt vmcnt(15)
    v_mfma_f32_32x32x16_bf16 v[32:47], v[96:99], a[72:75], v[32:47]
    buffer_load_dwordx4 a[152:155], v4, s[52:55], s79 offen offset:2048 sc1
    ds_read_b64_tr_b16 v[104:105], v233 offset:24576
    ds_read_b64_tr_b16 v[106:107], v233 offset:25600
    v_mfma_f32_32x32x16_bf16 v[48:63], v[108:111], a[72:75], v[48:63]
    ds_read_b64_tr_b16 v[116:117], v235 offset:24576
    ds_read_b64_tr_b16 v[118:119], v235 offset:25600
    v_mfma_f32_32x32x16_bf16 v[64:79], v[120:123], a[72:75], v[64:79]
    buffer_load_dwordx4 a[156:159], v4, s[52:55], s79 offen offset:3072 sc1
    ds_read_b64_tr_b16 v[128:129], v237 offset:24576
    ds_read_b64_tr_b16 v[130:131], v237 offset:25600
    s_waitcnt lgkmcnt(6)
    s_waitcnt vmcnt(16)
    v_mfma_f32_32x32x16_bf16 v[32:47], v[100:103], a[76:79], v[32:47]
    ds_read_b64_tr_b16 v[96:97], v233 offset:28672
    ds_read_b64_tr_b16 v[98:99], v233 offset:29696
    v_mfma_f32_32x32x16_bf16 v[48:63], v[112:115], a[76:79], v[48:63]
    s_cmp_ge_u32 s87, 11
    s_cselect_b32 s79, s86, s35
    s_add_u32 s79, s79, 12288
    buffer_load_dwordx4 a[160:163], v4, s[52:55], s79 offen offset:0 sc1
    ds_read_b64_tr_b16 v[108:109], v235 offset:28672
    ds_read_b64_tr_b16 v[110:111], v235 offset:29696
    v_mfma_f32_32x32x16_bf16 v[64:79], v[124:127], a[76:79], v[64:79]
    ds_read_b64_tr_b16 v[120:121], v237 offset:28672
    ds_read_b64_tr_b16 v[122:123], v237 offset:29696
    s_waitcnt lgkmcnt(6)
    s_waitcnt vmcnt(16)
    v_mfma_f32_32x32x16_bf16 v[32:47], v[104:107], a[80:83], v[32:47]
    buffer_load_dwordx4 a[164:167], v4, s[52:55], s79 offen offset:1024 sc1
    ds_read_b64_tr_b16 v[100:101], v233 offset:32768
    ds_read_b64_tr_b16 v[102:103], v233 offset:33792
    v_mfma_f32_32x32x16_bf16 v[48:63], v[116:119], a[80:83], v[48:63]
    ds_read_b64_tr_b16 v[112:113], v235 offset:32768
    ds_read_b64_tr_b16 v[114:115], v235 offset:33792
    v_mfma_f32_32x32x16_bf16 v[64:79], v[128:131], a[80:83], v[64:79]
    ds_read_b64_tr_b16 v[124:125], v237 offset:32768
    ds_read_b64_tr_b16 v[126:127], v237 offset:33792
    s_waitcnt lgkmcnt(6)
    s_waitcnt vmcnt(16)
    v_mfma_f32_32x32x16_bf16 v[32:47], v[96:99], a[84:87], v[32:47]
    buffer_load_dwordx4 a[168:171], v4, s[52:55], s79 offen offset:2048 sc1
    ds_read_b64_tr_b16 v[104:105], v233 offset:36864
    ds_read_b64_tr_b16 v[106:107], v233 offset:37888
    v_mfma_f32_32x32x16_bf16 v[48:63], v[108:111], a[84:87], v[48:63]
    ds_read_b64_tr_b16 v[116:117], v235 offset:36864
    ds_read_b64_tr_b16 v[118:119], v235 offset:37888
    v_mfma_f32_32x32x16_bf16 v[64:79], v[120:123], a[84:87], v[64:79]
    buffer_load_dwordx4 a[172:175], v4, s[52:55], s79 offen offset:3072 sc1
    ds_read_b64_tr_b16 v[128:129], v237 offset:36864
    ds_read_b64_tr_b16 v[130:131], v237 offset:37888
    s_waitcnt lgkmcnt(6)
    s_waitcnt vmcnt(17)
    v_mfma_f32_32x32x16_bf16 v[32:47], v[100:103], a[88:91], v[32:47]
    ds_read_b64_tr_b16 v[96:97], v233 offset:40960
    ds_read_b64_tr_b16 v[98:99], v233 offset:41984
    v_mfma_f32_32x32x16_bf16 v[48:63], v[112:115], a[88:91], v[48:63]
    s_cmp_ge_u32 s87, 10
    s_cselect_b32 s79, s86, s35
    s_add_u32 s79, s79, 16384
    buffer_load_dwordx4 a[176:179], v4, s[52:55], s79 offen offset:0 sc1
    ds_read_b64_tr_b16 v[108:109], v235 offset:40960
    ds_read_b64_tr_b16 v[110:111], v235 offset:41984
    v_mfma_f32_32x32x16_bf16 v[64:79], v[124:127], a[88:91], v[64:79]
    ds_read_b64_tr_b16 v[120:121], v237 offset:40960
    ds_read_b64_tr_b16 v[122:123], v237 offset:41984
    s_waitcnt lgkmcnt(6)
    s_waitcnt vmcnt(17)
    v_mfma_f32_32x32x16_bf16 v[32:47], v[104:107], a[92:95], v[32:47]
    buffer_load_dwordx4 a[180:183], v4, s[52:55], s79 offen offset:1024 sc1
    ds_read_b64_tr_b16 v[100:101], v233 offset:45056
    ds_read_b64_tr_b16 v[102:103], v233 offset:46080
    v_mfma_f32_32x32x16_bf16 v[48:63], v[116:119], a[92:95], v[48:63]
    ds_read_b64_tr_b16 v[112:113], v235 offset:45056
    ds_read_b64_tr_b16 v[114:115], v235 offset:46080
    v_mfma_f32_32x32x16_bf16 v[64:79], v[128:131], a[92:95], v[64:79]
    buffer_load_dwordx4 a[184:187], v4, s[52:55], s79 offen offset:2048 sc1
    ds_read_b64_tr_b16 v[124:125], v237 offset:45056
    ds_read_b64_tr_b16 v[126:127], v237 offset:46080
    s_waitcnt lgkmcnt(6)
    s_waitcnt vmcnt(18)
    v_mfma_f32_32x32x16_bf16 v[32:47], v[96:99], a[96:99], v[32:47]
    ds_read_b64_tr_b16 v[104:105], v233 offset:49152
    ds_read_b64_tr_b16 v[106:107], v233 offset:50176
    v_mfma_f32_32x32x16_bf16 v[48:63], v[108:111], a[96:99], v[48:63]
    buffer_load_dwordx4 a[188:191], v4, s[52:55], s79 offen offset:3072 sc1
    ds_read_b64_tr_b16 v[116:117], v235 offset:49152
    ds_read_b64_tr_b16 v[118:119], v235 offset:50176
    v_mfma_f32_32x32x16_bf16 v[64:79], v[120:123], a[96:99], v[64:79]
    ds_read_b64_tr_b16 v[128:129], v237 offset:49152
    ds_read_b64_tr_b16 v[130:131], v237 offset:50176
    s_waitcnt lgkmcnt(6)
    s_waitcnt vmcnt(16)
    v_mfma_f32_32x32x16_bf16 v[32:47], v[100:103], a[100:103], v[32:47]
    s_cmp_ge_u32 s87, 9
    s_cselect_b32 s79, s86, s35
    s_add_u32 s79, s79, 20480
    buffer_load_dwordx4 a[192:195], v4, s[52:55], s79 offen offset:0 sc1
    ds_read_b64_tr_b16 v[96:97], v233 offset:53248
    ds_read_b64_tr_b16 v[98:99], v233 offset:54272
    v_mfma_f32_32x32x16_bf16 v[48:63], v[112:115], a[100:103], v[48:63]
    ds_read_b64_tr_b16 v[108:109], v235 offset:53248
    ds_read_b64_tr_b16 v[110:111], v235 offset:54272
    v_mfma_f32_32x32x16_bf16 v[64:79], v[124:127], a[100:103], v[64:79]
    buffer_load_dwordx4 a[196:199], v4, s[52:55], s79 offen offset:1024 sc1
    ds_read_b64_tr_b16 v[120:121], v237 offset:53248
    ds_read_b64_tr_b16 v[122:123], v237 offset:54272
    s_waitcnt lgkmcnt(6)
    s_waitcnt vmcnt(16)
    v_mfma_f32_32x32x16_bf16 v[32:47], v[104:107], a[104:107], v[32:47]
    v_mfma_f32_32x32x16_bf16 v[48:63], v[116:119], a[104:107], v[48:63]
    buffer_load_dwordx4 a[200:203], v4, s[52:55], s79 offen offset:2048 sc1
    v_mfma_f32_32x32x16_bf16 v[64:79], v[128:131], a[104:107], v[64:79]
    s_waitcnt lgkmcnt(0)
    s_waitcnt vmcnt(14)
    v_mfma_f32_32x32x16_bf16 v[32:47], v[96:99], a[108:111], v[32:47]
    buffer_load_dwordx4 a[204:207], v4, s[52:55], s79 offen offset:3072 sc1
    v_mfma_f32_32x32x16_bf16 v[48:63], v[108:111], a[108:111], v[48:63]
    v_mfma_f32_32x32x16_bf16 v[64:79], v[120:123], a[108:111], v[64:79]
    ds_read_b64_tr_b16 v[96:97], v238 offset:0
    ds_read_b64_tr_b16 v[98:99], v238 offset:1024
    ds_read_b64_tr_b16 v[100:101], v238 offset:4096
    ds_read_b64_tr_b16 v[102:103], v238 offset:5120
    s_waitcnt lgkmcnt(2)
    v_mfma_f32_32x32x16_bf16 v[80:95], v[96:99], a[0:3], 0
    ds_read_b64_tr_b16 v[104:105], v238 offset:8192
    ds_read_b64_tr_b16 v[106:107], v238 offset:9216
    s_waitcnt lgkmcnt(2)
    v_mfma_f32_32x32x16_bf16 v[80:95], v[100:103], a[4:7], v[80:95]
    v_cmp_u_f32 vcc, v32, v18
    s_nop 1
    s_cbranch_vccz ok_21
    s_cmp_eq_u32 s73, 2
    s_cbranch_scc1 ok_21
    s_mov_b32 s73, 2
    s_waitcnt vmcnt(0) lgkmcnt(0)
    s_add_u32 s44, s84, 1024
    v_lshlrev_b32 v30, 2, v1
    v_cmp_gt_u32 vcc, 56, v1
    s_nop 0
    s_mov_b64 exec, vcc
    s_mov_b32 s47, 0
poll_22:
    buffer_load_dword v31, v30, s[52:55], s44 offen sc1
    s_add_u32 s47, s47, 1
    s_waitcnt vmcnt(0)
    v_cmp_ne_u32 vcc, s72, v31
    s_cmp_gt_u32 s47, 200000
    s_cbranch_scc1 pollx_23
    s_sleep 1
    s_cbranch_vccnz poll_22
pollx_23:
    s_mov_b64 exec, -1
    s_branch p3_loads
ok_21:
    ds_read_b64_tr_b16 v[96:97], v238 offset:12288
    ds_read_b64_tr_b16 v[98:99], v238 offset:13312
    s_waitcnt lgkmcnt(2)
    v_mfma_f32_32x32x16_bf16 v[80:95], v[104:107], a[8:11], v[80:95]
    ds_read_b128 v[216:219], v21 offset:0
    ds_read_b128 v[220:223], v21 offset:32
    ds_read_b128 v[224:227], v21 offset:64
    ds_read_b128 v[228:231], v21 offset:96
    ds_read_b128 v[120:123], v21 offset:512
    ds_read_b64_tr_b16 v[100:101], v238 offset:16384
    ds_read_b64_tr_b16 v[102:103], v238 offset:17408
    s_waitcnt lgkmcnt(7)
    v_mfma_f32_32x32x16_bf16 v[80:95], v[96:99], a[12:15], v[80:95]
    ds_read_b128 v[124:127], v21 offset:544
    ds_read_b128 v[128:131], v21 offset:576
    ds_read_b128 v[132:135], v21 offset:608
    s_cmp_ge_u32 s87, 8
    s_cselect_b32 s79, s86, s35
    s_add_u32 s79, s79, 24576
    buffer_load_dwordx4 a[208:211], v4, s[52:55], s79 offen offset:0 sc1
    s_waitcnt lgkmcnt(6)
    v_fma_f32 v32, -v18, v216, v32
    ds_read_b64_tr_b16 v[104:105], v238 offset:20480
    ds_read_b64_tr_b16 v[106:107], v238 offset:21504
    s_waitcnt lgkmcnt(5)
    v_mfma_f32_32x32x16_bf16 v[80:95], v[100:103], a[16:19], v[80:95]
    v_fma_f32 v33, -v18, v217, v33
    v_fma_f32 v34, -v18, v218, v34
    v_fma_f32 v35, -v18, v219, v35
    v_fma_f32 v36, -v18, v220, v36
    v_fma_f32 v37, -v18, v221, v37
    ds_read_b64_tr_b16 v[96:97], v238 offset:24576
    ds_read_b64_tr_b16 v[98:99], v238 offset:25600
    s_waitcnt lgkmcnt(2)
    v_mfma_f32_32x32x16_bf16 v[80:95], v[104:107], a[20:23], v[80:95]
    v_fma_f32 v38, -v18, v222, v38
    buffer_load_dwordx4 a[212:215], v4, s[52:55], s79 offen offset:1024 sc1
    v_fma_f32 v39, -v18, v223, v39
    v_fma_f32 v40, -v18, v224, v40
    v_fma_f32 v41, -v18, v225, v41
    ds_read_b64_tr_b16 v[100:101], v238 offset:28672
    ds_read_b64_tr_b16 v[102:103], v238 offset:29696
    s_waitcnt lgkmcnt(2)
    v_mfma_f32_32x32x16_bf16 v[80:95], v[96:99], a[24:27], v[80:95]
    v_fma_f32 v42, -v18, v226, v42
    v_fma_f32 v43, -v18, v227, v43
    v_fma_f32 v44, -v18, v228, v44
    v_fma_f32 v45, -v18, v229, v45
    v_fma_f32 v46, -v18, v230, v46
    ds_read_b64_tr_b16 v[104:105], v238 offset:32768
    ds_read_b64_tr_b16 v[106:107], v238 offset:33792
    s_waitcnt lgkmcnt(2)
    v_mfma_f32_32x32x16_bf16 v[80:95], v[100:103], a[28:31], v[80:95]
    buffer_load_dwordx4 a[216:219], v4, s[52:55], s79 offen offset:2048 sc1
    v_fma_f32 v47, -v18, v231, v47
    v_fma_f32 v32, v19, v32, v120
    v_fma_f32 v33, v19, v33, v121
    v_fma_f32 v34, v19, v34, v122
    ds_read_b64_tr_b16 v[96:97], v238 offset:36864
    ds_read_b64_tr_b16 v[98:99], v238 offset:37888
    s_waitcnt lgkmcnt(2)
    v_mfma_f32_32x32x16_bf16 v[80:95], v[104:107], a[32:35], v[80:95]
    v_fma_f32 v35, v19, v35, v123
    v_fma_f32 v36, v19, v36, v124
    v_fma_f32 v37, v19, v37, v125
    buffer_load_dwordx4 a[220:223], v4, s[52:55], s79 offen offset:3072 sc1
    v_fma_f32 v38, v19, v38, v126
    ds_read_b64_tr_b16 v[100:101], v238 offset:40960
    ds_read_b64_tr_b16 v[102:103], v238 offset:41984
    s_waitcnt lgkmcnt(2)
    v_mfma_f32_32x32x16_bf16 v[80:95], v[96:99], a[36:39], v[80:95]
    v_fma_f32 v39, v19, v39, v127
    v_fma_f32 v40, v19, v40, v128
    v_fma_f32 v41, v19, v41, v129
    v_fma_f32 v42, v19, v42, v130
    v_fma_f32 v43, v19, v43, v131
    ds_read_b64_tr_b16 v[104:105], v238 offset:45056
    ds_read_b64_tr_b16 v[106:107], v238 offset:46080
    s_waitcnt lgkmcnt(2)
    v_mfma_f32_32x32x16_bf16 v[80:95], v[100:103], a[40:43], v[80:95]
    v_fma_f32 v44, v19, v44, v132
    v_fma_f32 v45, v19, v45, v133
    s_cmp_ge_u32 s87, 7
    s_cselect_b32 s79, s86, s35
    s_add_u32 s79, s79, 28672
    buffer_load_dwordx4 a[224:227], v4, s[52:55], s79 offen offset:0 sc1
    v_fma_f32 v46, v19, v46, v134
    v_fma_f32 v47, v19, v47, v135
    ds_read_b64_tr_b16 v[96:97], v238 offset:49152
    ds_read_b64_tr_b16 v[98:99], v238 offset:50176
    s_waitcnt lgkmcnt(2)
    v_mfma_f32_32x32x16_bf16 v[80:95], v[104:107], a[44:47], v[80:95]
    v_mul_f32 v120, v240, v32
    v_mul_f32 v121, v240, v33
    v_mul_f32 v122, v240, v34
    v_mul_f32 v123, v240, v35
    v_mul_f32 v124, v240, v36
    ds_read_b64_tr_b16 v[100:101], v238 offset:53248
    ds_read_b64_tr_b16 v[102:103], v238 offset:54272
    s_waitcnt lgkmcnt(2)
    v_mfma_f32_32x32x16_bf16 v[80:95], v[96:99], a[48:51], v[80:95]
    v_mul_f32 v125, v240, v37
    buffer_load_dwordx4 a[228:231], v4, s[52:55], s79 offen offset:1024 sc1
    v_mul_f32 v126, v240, v38
    v_mul_f32 v127, v240, v39
    v_mul_f32 v128, v240, v40
    ds_read_b64_tr_b16 v[104:105], v239 offset:0
    ds_read_b64_tr_b16 v[106:107], v239 offset:1024
    s_waitcnt lgkmcnt(2)
    v_mfma_f32_32x32x16_bf16 v[80:95], v[100:103], a[52:55], v[80:95]
    v_mul_f32 v129, v240, v41
    v_mul_f32 v130, v240, v42
    v_mul_f32 v131, v240, v43
    v_mul_f32 v132, v240, v44
    v_mul_f32 v133, v240, v45
    ds_read_b64_tr_b16 v[96:97], v239 offset:4096
    ds_read_b64_tr_b16 v[98:99], v239 offset:5120
    s_waitcnt lgkmcnt(2)
    v_mfma_f32_32x32x16_bf16 v[80:95], v[104:107], a[56:59], v[80:95]
    buffer_load_dwordx4 a[232:235], v4, s[52:55], s79 offen offset:2048 sc1
    v_mul_f32 v134, v240, v46
    v_mul_f32 v135, v240, v47
    v_exp_f32 v120, v120
    v_exp_f32 v121, v121
    ds_read_b64_tr_b16 v[100:101], v239 offset:8192
    ds_read_b64_tr_b16 v[102:103], v239 offset:9216
    s_waitcnt lgkmcnt(2)
    v_mfma_f32_32x32x16_bf16 v[80:95], v[96:99], a[60:63], v[80:95]
    v_exp_f32 v122, v122
    v_exp_f32 v123, v123
    v_exp_f32 v124, v124
    v_exp_f32 v125, v125
    buffer_load_dwordx4 a[236:239], v4, s[52:55], s79 offen offset:3072 sc1
    ds_read_b64_tr_b16 v[104:105], v239 offset:12288
    ds_read_b64_tr_b16 v[106:107], v239 offset:13312
    s_waitcnt lgkmcnt(2)
    v_mfma_f32_32x32x16_bf16 v[80:95], v[100:103], a[64:67], v[80:95]
    v_exp_f32 v126, v126
    v_exp_f32 v127, v127
    v_exp_f32 v128, v128
    v_exp_f32 v129, v129
    v_exp_f32 v130, v130
    ds_read_b64_tr_b16 v[96:97], v239 offset:16384
    ds_read_b64_tr_b16 v[98:99], v239 offset:17408
    s_waitcnt lgkmcnt(2)
    v_mfma_f32_32x32x16_bf16 v[80:95], v[104:107], a[68:71], v[80:95]
    v_exp_f32 v131, v131
    v_exp_f32 v132, v132
    v_exp_f32 v133, v133
    s_cmp_ge_u32 s87, 6
    s_cselect_b32 s79, s86, s35
    s_add_u32 s79, s79, 32768
    buffer_load_dwordx4 a[240:243], v4, s[52:55], s79 offen offset:0 sc1
    v_exp_f32 v134, v134
    ds_read_b64_tr_b16 v[100:101], v239 offset:20480
    ds_read_b64_tr_b16 v[102:103], v239 offset:21504
    s_waitcnt lgkmcnt(2)
    v_mfma_f32_32x32x16_bf16 v[80:95], v[96:99], a[72:75], v[80:95]
    v_exp_f32 v135, v135
    v_add_f32 v120, 1.0, v120
    v_add_f32 v121, 1.0, v121
    v_add_f32 v122, 1.0, v122
    v_add_f32 v123, 1.0, v123
    ds_read_b64_tr_b16 v[104:105], v239 offset:24576
    ds_read_b64_tr_b16 v[106:107], v239 offset:25600
    s_waitcnt lgkmcnt(2)
    v_mfma_f32_32x32x16_bf16 v[80:95], v[100:103], a[76:79], v[80:95]
    v_add_f32 v124, 1.0, v124
    v_add_f32 v125, 1.0, v125
    buffer_load_dwordx4 a[244:247], v4, s[52:55], s79 offen offset:1024 sc1
    v_add_f32 v126, 1.0, v126
    v_add_f32 v127, 1.0, v127
    ds_read_b64_tr_b16 v[96:97], v239 offset:28672
    ds_read_b64_tr_b16 v[98:99], v239 offset:29696
    s_waitcnt lgkmcnt(2)
    v_mfma_f32_32x32x16_bf16 v[80:95], v[104:107], a[80:83], v[80:95]
    v_add_f32 v128, 1.0, v128
    v_add_f32 v129, 1.0, v129
    v_add_f32 v130, 1.0, v130
    v_add_f32 v131, 1.0, v131
    v_add_f32 v132, 1.0, v132
    ds_read_b64_tr_b16 v[100:101], v239 offset:32768
    ds_read_b64_tr_b16 v[102:103], v239 offset:33792
    s_waitcnt lgkmcnt(2)
    v_mfma_f32_32x32x16_bf16 v[80:95], v[96:99], a[84:87], v[80:95]
    v_add_f32 v133, 1.0, v133
    buffer_load_dwordx4 a[248:251], v4, s[52:55], s79 offen offset:2048 sc1
    v_add_f32 v134, 1.0, v134
    v_add_f32 v135, 1.0, v135
    v_rcp_f32 v120, v120
    ds_read_b64_tr_b16 v[104:105], v239 offset:36864
    ds_read_b64_tr_b16 v[106:107], v239 offset:37888
    s_waitcnt lgkmcnt(2)
    v_mfma_f32_32x32x16_bf16 v[80:95], v[100:103], a[88:91], v[80:95]
    v_rcp_f32 v121, v121
    v_rcp_f32 v122, v122
    v_rcp_f32 v123, v123
    v_rcp_f32 v124, v124
    v_rcp_f32 v125, v125
    ds_read_b64_tr_b16 v[96:97], v239 offset:40960
    ds_read_b64_tr_b16 v[98:99], v239 offset:41984
    s_waitcnt lgkmcnt(2)
    v_mfma_f32_32x32x16_bf16 v[80:95], v[104:107], a[92:95], v[80:95]
    buffer_load_dwordx4 a[252:255], v4, s[52:55], s79 offen offset:3072 sc1
    v_rcp_f32 v126, v126
    v_rcp_f32 v127, v127
    v_rcp_f32 v128, v128
    v_rcp_f32 v129, v129
    ds_read_b64_tr_b16 v[100:101], v239 offset:45056
    ds_read_b64_tr_b16 v[102:103], v239 offset:46080
    s_waitcnt lgkmcnt(2)
    v_mfma_f32_32x32x16_bf16 v[80:95], v[96:99], a[96:99], v[80:95]
    v_rcp_f32 v130, v130
    v_rcp_f32 v131, v131
    v_rcp_f32 v132, v132
    v_rcp_f32 v133, v133
    s_cmp_ge_u32 s87, 5
    s_cselect_b32 s79, s86, s35
    s_add_u32 s79, s79, 36864
    buffer_load_dwordx4 v[136:139], v4, s[52:55], s79 offen offset:0 sc1
    ds_read_b64_tr_b16 v[104:105], v239 offset:49152
    ds_read_b64_tr_b16 v[106:107], v239 offset:50176
    s_waitcnt lgkmcnt(2)
    v_mfma_f32_32x32x16_bf16 v[80:95], v[100:103], a[100:103], v[80:95]
    v_rcp_f32 v134, v134
    v_rcp_f32 v135, v135
    v_mul_f32 v32, v32, v120
    v_mul_f32 v33, v33, v121
    v_mul_f32 v34, v34, v122
    ds_read_b64_tr_b16 v[96:97], v239 offset:53248
    ds_read_b64_tr_b16 v[98:99], v239 offset:54272
    s_waitcnt lgkmcnt(2)
    v_mfma_f32_32x32x16_bf16 v[80:95], v[104:107], a[104:107], v[80:95]
    v_mul_f32 v35, v35, v123
    v_mul_f32 v36, v36, v124
    v_mul_f32 v37, v37, v125
    buffer_load_dwordx4 v[140:143], v4, s[52:55], s79 offen offset:1024 sc1
    v_mul_f32 v38, v38, v126
    s_waitcnt lgkmcnt(0)
    v_mfma_f32_32x32x16_bf16 v[80:95], v[96:99], a[108:111], v[80:95]
    v_mul_f32 v39, v39, v127
    v_mul_f32 v40, v40, v128
    v_mul_f32 v41, v41, v129
    v_mul_f32 v42, v42, v130
    v_mul_f32 v43, v43, v131
    v_mul_f32 v44, v44, v132
    v_mul_f32 v45, v45, v133
    buffer_load_dwordx4 v[144:147], v4, s[52:55], s79 offen offset:2048 sc1
    v_mul_f32 v46, v46, v134
    v_mul_f32 v47, v47, v135
    v_cvt_pk_bf16_f32 v32, v32, v33
    v_cvt_pk_bf16_f32 v33, v34, v35
    v_cvt_pk_bf16_f32 v34, v36, v37
    v_cvt_pk_bf16_f32 v35, v38, v39
    v_cvt_pk_bf16_f32 v36, v40, v41
    v_cvt_pk_bf16_f32 v37, v42, v43
    buffer_load_dwordx4 v[148:151], v4, s[52:55], s79 offen offset:3072 sc1
    v_cvt_pk_bf16_f32 v38, v44, v45
    v_cvt_pk_bf16_f32 v39, v46, v47
    v_permlane32_swap_b32 v32, v34
    v_permlane32_swap_b32 v33, v35
    buffer_store_dwordx4 v[32:35], v17, s[52:55], s32 offen offset:0 sc1
    v_permlane32_swap_b32 v36, v38
    v_permlane32_swap_b32 v37, v39
    buffer_store_dwordx4 v[36:39], v17, s[52:55], s32 offen offset:512 sc1
    ds_read_b128 v[216:219], v21 offset:128
    ds_read_b128 v[220:223], v21 offset:160
    ds_read_b128 v[224:227], v21 offset:192
    ds_read_b128 v[228:231], v21 offset:224
    ds_read_b128 v[120:123], v21 offset:640
    ds_read_b128 v[124:127], v21 offset:672
    s_cmp_ge_u32 s87, 4
    s_cselect_b32 s79, s86, s35
    s_add_u32 s79, s79, 40960
    buffer_load_dwordx4 v[152:155], v4, s[52:55], s79 offen offset:0 sc1
    ds_read_b128 v[128:131], v21 offset:704
    ds_read_b128 v[132:135], v21 offset:736
    s_waitcnt lgkmcnt(4)
    v_pk_fma_f32 v[48:49], v[18:19], v[216:217], v[48:49] op_sel_hi:[0,1,1] neg_lo:[1,0,0] neg_hi:[1,0,0]
    v_pk_fma_f32 v[50:51], v[18:19], v[218:219], v[50:51] op_sel_hi:[0,1,1] neg_lo:[1,0,0] neg_hi:[1,0,0]
    v_pk_fma_f32 v[52:53], v[18:19], v[220:221], v[52:53] op_sel_hi:[0,1,1] neg_lo:[1,0,0] neg_hi:[1,0,0]
    buffer_load_dwordx4 v[156:159], v4, s[52:55], s79 offen offset:1024 sc1
    v_pk_fma_f32 v[54:55], v[18:19], v[222:223], v[54:55] op_sel_hi:[0,1,1] neg_lo:[1,0,0] neg_hi:[1,0,0]
    v_pk_fma_f32 v[56:57], v[18:19], v[224:225], v[56:57] op_sel_hi:[0,1,1] neg_lo:[1,0,0] neg_hi:[1,0,0]
    v_pk_fma_f32 v[58:59], v[18:19], v[226:227], v[58:59] op_sel_hi:[0,1,1] neg_lo:[1,0,0] neg_hi:[1,0,0]
    v_pk_fma_f32 v[60:61], v[18:19], v[228:229], v[60:61] op_sel_hi:[0,1,1] neg_lo:[1,0,0] neg_hi:[1,0,0]
    v_pk_fma_f32 v[62:63], v[18:19], v[230:231], v[62:63] op_sel_hi:[0,1,1] neg_lo:[1,0,0] neg_hi:[1,0,0]
    s_waitcnt lgkmcnt(0)
    buffer_load_dwordx4 v[160:163], v4, s[52:55], s79 offen offset:2048 sc1
    v_pk_fma_f32 v[48:49], v[18:19], v[48:49], v[120:121] op_sel:[1,0,0] op_sel_hi:[1,1,1]
    v_pk_fma_f32 v[50:51], v[18:19], v[50:51], v[122:123] op_sel:[1,0,0] op_sel_hi:[1,1,1]
    v_pk_fma_f32 v[52:53], v[18:19], v[52:53], v[124:125] op_sel:[1,0,0] op_sel_hi:[1,1,1]
    v_pk_fma_f32 v[54:55], v[18:19], v[54:55], v[126:127] op_sel:[1,0,0] op_sel_hi:[1,1,1]
    v_pk_fma_f32 v[56:57], v[18:19], v[56:57], v[128:129] op_sel:[1,0,0] op_sel_hi:[1,1,1]
    v_pk_fma_f32 v[58:59], v[18:19], v[58:59], v[130:131] op_sel:[1,0,0] op_sel_hi:[1,1,1]
    buffer_load_dwordx4 v[164:167], v4, s[52:55], s79 offen offset:3072 sc1
    v_pk_fma_f32 v[60:61], v[18:19], v[60:61], v[132:133] op_sel:[1,0,0] op_sel_hi:[1,1,1]
    v_pk_fma_f32 v[62:63], v[18:19], v[62:63], v[134:135] op_sel:[1,0,0] op_sel_hi:[1,1,1]
    ds_read_b128 v[96:99], v21 offset:256
    ds_read_b128 v[100:103], v21 offset:288
    ds_read_b128 v[104:107], v21 offset:320
    ds_read_b128 v[108:111], v21 offset:352
    v_pk_mul_f32 v[120:121], v[48:49], v[240:241]
    v_pk_mul_f32 v[122:123], v[50:51], v[240:241]
    v_pk_mul_f32 v[124:125], v[52:53], v[240:241]
    v_pk_mul_f32 v[126:127], v[54:55], v[240:241]
    v_pk_mul_f32 v[128:129], v[56:57], v[240:241]
    v_pk_mul_f32 v[130:131], v[58:59], v[240:241]
    v_pk_mul_f32 v[132:133], v[60:61], v[240:241]
    v_pk_mul_f32 v[134:135], v[62:63], v[240:241]
    v_exp_f32 v120, v120
    v_exp_f32 v121, v121
    v_exp_f32 v122, v122
    v_exp_f32 v123, v123
    v_exp_f32 v124, v124
    v_exp_f32 v125, v125
    v_exp_f32 v126, v126
    v_exp_f32 v127, v127
    v_exp_f32 v128, v128
    v_exp_f32 v129, v129
    v_exp_f32 v130, v130
    v_exp_f32 v131, v131
    v_exp_f32 v132, v132
    v_exp_f32 v133, v133
    v_exp_f32 v134, v134
    v_exp_f32 v135, v135
    v_pk_add_f32 v[120:121], v[120:121], v[242:243]
    v_pk_add_f32 v[122:123], v[122:123], v[242:243]
    v_pk_add_f32 v[124:125], v[124:125], v[242:243]
    v_pk_add_f32 v[126:127], v[126:127], v[242:243]
    v_pk_add_f32 v[128:129], v[128:129], v[242:243]
    v_pk_add_f32 v[130:131], v[130:131], v[242:243]
    v_pk_add_f32 v[132:133], v[132:133], v[242:243]
    v_pk_add_f32 v[134:135], v[134:135], v[242:243]
    v_rcp_f32 v120, v120
    v_rcp_f32 v121, v121
    v_rcp_f32 v122, v122
    v_rcp_f32 v123, v123
    v_rcp_f32 v124, v124
    v_rcp_f32 v125, v125
    v_rcp_f32 v126, v126
    v_rcp_f32 v127, v127
    v_rcp_f32 v128, v128
    v_rcp_f32 v129, v129
    v_rcp_f32 v130, v130
    v_rcp_f32 v131, v131
    v_rcp_f32 v132, v132
    v_rcp_f32 v133, v133
    v_rcp_f32 v134, v134
    v_rcp_f32 v135, v135
    v_pk_mul_f32 v[48:49], v[48:49], v[120:121]
    v_pk_mul_f32 v[50:51], v[50:51], v[122:123]
    v_pk_mul_f32 v[52:53], v[52:53], v[124:125]
    v_pk_mul_f32 v[54:55], v[54:55], v[126:127]
    v_pk_mul_f32 v[56:57], v[56:57], v[128:129]
    v_pk_mul_f32 v[58:59], v[58:59], v[130:131]
    v_pk_mul_f32 v[60:61], v[60:61], v[132:133]
    v_pk_mul_f32 v[62:63], v[62:63], v[134:135]
    v_cvt_pk_bf16_f32 v48, v48, v49
    v_cvt_pk_bf16_f32 v49, v50, v51
    v_cvt_pk_bf16_f32 v50, v52, v53
    v_cvt_pk_bf16_f32 v51, v54, v55
    v_cvt_pk_bf16_f32 v52, v56, v57
    v_cvt_pk_bf16_f32 v53, v58, v59
    v_cvt_pk_bf16_f32 v54, v60, v61
    v_cvt_pk_bf16_f32 v55, v62, v63
    v_permlane32_swap_b32 v48, v50
    v_permlane32_swap_b32 v49, v51
    buffer_store_dwordx4 v[48:51], v17, s[52:55], s32 offen offset:1024 sc1
    v_permlane32_swap_b32 v52, v54
    v_permlane32_swap_b32 v53, v55
    buffer_store_dwordx4 v[52:55], v17, s[52:55], s32 offen offset:1536 sc1
    ds_read_b128 v[120:123], v21 offset:768
    ds_read_b128 v[124:127], v21 offset:800
    ds_read_b128 v[128:131], v21 offset:832
    ds_read_b128 v[132:135], v21 offset:864
    s_waitcnt lgkmcnt(4)
    v_pk_fma_f32 v[64:65], v[18:19], v[96:97], v[64:65] op_sel_hi:[0,1,1] neg_lo:[1,0,0] neg_hi:[1,0,0]
    v_pk_fma_f32 v[66:67], v[18:19], v[98:99], v[66:67] op_sel_hi:[0,1,1] neg_lo:[1,0,0] neg_hi:[1,0,0]
    v_pk_fma_f32 v[68:69], v[18:19], v[100:101], v[68:69] op_sel_hi:[0,1,1] neg_lo:[1,0,0] neg_hi:[1,0,0]
    v_pk_fma_f32 v[70:71], v[18:19], v[102:103], v[70:71] op_sel_hi:[0,1,1] neg_lo:[1,0,0] neg_hi:[1,0,0]
    v_pk_fma_f32 v[72:73], v[18:19], v[104:105], v[72:73] op_sel_hi:[0,1,1] neg_lo:[1,0,0] neg_hi:[1,0,0]
    v_pk_fma_f32 v[74:75], v[18:19], v[106:107], v[74:75] op_sel_hi:[0,1,1] neg_lo:[1,0,0] neg_hi:[1,0,0]
    v_pk_fma_f32 v[76:77], v[18:19], v[108:109], v[76:77] op_sel_hi:[0,1,1] neg_lo:[1,0,0] neg_hi:[1,0,0]
    v_pk_fma_f32 v[78:79], v[18:19], v[110:111], v[78:79] op_sel_hi:[0,1,1] neg_lo:[1,0,0] neg_hi:[1,0,0]
    s_waitcnt lgkmcnt(0)
    v_pk_fma_f32 v[64:65], v[18:19], v[64:65], v[120:121] op_sel:[1,0,0] op_sel_hi:[1,1,1]
    v_pk_fma_f32 v[66:67], v[18:19], v[66:67], v[122:123] op_sel:[1,0,0] op_sel_hi:[1,1,1]
    v_pk_fma_f32 v[68:69], v[18:19], v[68:69], v[124:125] op_sel:[1,0,0] op_sel_hi:[1,1,1]
    v_pk_fma_f32 v[70:71], v[18:19], v[70:71], v[126:127] op_sel:[1,0,0] op_sel_hi:[1,1,1]
    v_pk_fma_f32 v[72:73], v[18:19], v[72:73], v[128:129] op_sel:[1,0,0] op_sel_hi:[1,1,1]
    v_pk_fma_f32 v[74:75], v[18:19], v[74:75], v[130:131] op_sel:[1,0,0] op_sel_hi:[1,1,1]
    v_pk_fma_f32 v[76:77], v[18:19], v[76:77], v[132:133] op_sel:[1,0,0] op_sel_hi:[1,1,1]
    v_pk_fma_f32 v[78:79], v[18:19], v[78:79], v[134:135] op_sel:[1,0,0] op_sel_hi:[1,1,1]
    ds_read_b128 v[216:219], v21 offset:384
    ds_read_b128 v[220:223], v21 offset:416
    ds_read_b128 v[224:227], v21 offset:448
    ds_read_b128 v[228:231], v21 offset:480
    v_pk_mul_f32 v[120:121], v[64:65], v[240:241]
    v_pk_mul_f32 v[122:123], v[66:67], v[240:241]
    v_pk_mul_f32 v[124:125], v[68:69], v[240:241]
    v_pk_mul_f32 v[126:127], v[70:71], v[240:241]
    v_pk_mul_f32 v[128:129], v[72:73], v[240:241]
    v_pk_mul_f32 v[130:131], v[74:75], v[240:241]
    v_pk_mul_f32 v[132:133], v[76:77], v[240:241]
    v_pk_mul_f32 v[134:135], v[78:79], v[240:241]
    v_exp_f32 v120, v120
    v_exp_f32 v121, v121
    v_exp_f32 v122, v122
    v_exp_f32 v123, v123
    v_exp_f32 v124, v124
    v_exp_f32 v125, v125
    v_exp_f32 v126, v126
    v_exp_f32 v127, v127
    s_waitcnt vmcnt(45)
    v_exp_f32 v128, v128
    v_exp_f32 v129, v129
    v_exp_f32 v130, v130
    v_exp_f32 v131, v131
    v_exp_f32 v132, v132
    v_exp_f32 v133, v133
    v_exp_f32 v134, v134
    v_exp_f32 v135, v135
    v_pk_add_f32 v[120:121], v[120:121], v[242:243]
    v_pk_add_f32 v[122:123], v[122:123], v[242:243]
    v_pk_add_f32 v[124:125], v[124:125], v[242:243]
    v_pk_add_f32 v[126:127], v[126:127], v[242:243]
    v_pk_add_f32 v[128:129], v[128:129], v[242:243]
    v_pk_add_f32 v[130:131], v[130:131], v[242:243]
    v_pk_add_f32 v[132:133], v[132:133], v[242:243]
    v_pk_add_f32 v[134:135], v[134:135], v[242:243]
    v_rcp_f32 v120, v120
    v_rcp_f32 v121, v121
    v_rcp_f32 v122, v122
    v_rcp_f32 v123, v123
    v_rcp_f32 v124, v124
    v_rcp_f32 v125, v125
    v_rcp_f32 v126, v126
    v_rcp_f32 v127, v127
    v_rcp_f32 v128, v128
    v_rcp_f32 v129, v129
    v_rcp_f32 v130, v130
    v_rcp_f32 v131, v131
    v_rcp_f32 v132, v132
    v_rcp_f32 v133, v133
    v_rcp_f32 v134, v134
    v_rcp_f32 v135, v135
    v_pk_mul_f32 v[64:65], v[64:65], v[120:121]
    v_pk_mul_f32 v[66:67], v[66:67], v[122:123]
    v_pk_mul_f32 v[68:69], v[68:69], v[124:125]
    v_pk_mul_f32 v[70:71], v[70:71], v[126:127]
    v_pk_mul_f32 v[72:73], v[72:73], v[128:129]
    v_pk_mul_f32 v[74:75], v[74:75], v[130:131]
    v_pk_mul_f32 v[76:77], v[76:77], v[132:133]
    v_pk_mul_f32 v[78:79], v[78:79], v[134:135]
    v_cvt_pk_bf16_f32 v64, v64, v65
    v_cvt_pk_bf16_f32 v65, v66, v67
    v_cvt_pk_bf16_f32 v66, v68, v69
    v_cvt_pk_bf16_f32 v67, v70, v71
    v_cvt_pk_bf16_f32 v68, v72, v73
    v_cvt_pk_bf16_f32 v69, v74, v75
    v_cvt_pk_bf16_f32 v70, v76, v77
    v_cvt_pk_bf16_f32 v71, v78, v79
    v_permlane32_swap_b32 v64, v66
    v_permlane32_swap_b32 v65, v67
    buffer_store_dwordx4 v[64:67], v17, s[52:55], s32 offen offset:2048 sc1
    v_permlane32_swap_b32 v68, v70
    v_permlane32_swap_b32 v69, v71
    buffer_store_dwordx4 v[68:71], v17, s[52:55], s32 offen offset:2560 sc1
    ds_read_b128 v[120:123], v21 offset:896
    ds_read_b128 v[124:127], v21 offset:928
    ds_read_b128 v[128:131], v21 offset:960
    ds_read_b128 v[132:135], v21 offset:992
    s_waitcnt lgkmcnt(4)
    v_pk_fma_f32 v[80:81], v[18:19], v[216:217], v[80:81] op_sel_hi:[0,1,1] neg_lo:[1,0,0] neg_hi:[1,0,0]
    v_pk_fma_f32 v[82:83], v[18:19], v[218:219], v[82:83] op_sel_hi:[0,1,1] neg_lo:[1,0,0] neg_hi:[1,0,0]
    v_pk_fma_f32 v[84:85], v[18:19], v[220:221], v[84:85] op_sel_hi:[0,1,1] neg_lo:[1,0,0] neg_hi:[1,0,0]
    v_pk_fma_f32 v[86:87], v[18:19], v[222:223], v[86:87] op_sel_hi:[0,1,1] neg_lo:[1,0,0] neg_hi:[1,0,0]
    v_pk_fma_f32 v[88:89], v[18:19], v[224:225], v[88:89] op_sel_hi:[0,1,1] neg_lo:[1,0,0] neg_hi:[1,0,0]
    v_pk_fma_f32 v[90:91], v[18:19], v[226:227], v[90:91] op_sel_hi:[0,1,1] neg_lo:[1,0,0] neg_hi:[1,0,0]
    v_pk_fma_f32 v[92:93], v[18:19], v[228:229], v[92:93] op_sel_hi:[0,1,1] neg_lo:[1,0,0] neg_hi:[1,0,0]
    v_pk_fma_f32 v[94:95], v[18:19], v[230:231], v[94:95] op_sel_hi:[0,1,1] neg_lo:[1,0,0] neg_hi:[1,0,0]
    s_waitcnt lgkmcnt(0)
    v_pk_fma_f32 v[80:81], v[18:19], v[80:81], v[120:121] op_sel:[1,0,0] op_sel_hi:[1,1,1]
    v_pk_fma_f32 v[82:83], v[18:19], v[82:83], v[122:123] op_sel:[1,0,0] op_sel_hi:[1,1,1]
    v_pk_fma_f32 v[84:85], v[18:19], v[84:85], v[124:125] op_sel:[1,0,0] op_sel_hi:[1,1,1]
    v_pk_fma_f32 v[86:87], v[18:19], v[86:87], v[126:127] op_sel:[1,0,0] op_sel_hi:[1,1,1]
    v_pk_fma_f32 v[88:89], v[18:19], v[88:89], v[128:129] op_sel:[1,0,0] op_sel_hi:[1,1,1]
    v_pk_fma_f32 v[90:91], v[18:19], v[90:91], v[130:131] op_sel:[1,0,0] op_sel_hi:[1,1,1]
    v_pk_fma_f32 v[92:93], v[18:19], v[92:93], v[132:133] op_sel:[1,0,0] op_sel_hi:[1,1,1]
    v_pk_fma_f32 v[94:95], v[18:19], v[94:95], v[134:135] op_sel:[1,0,0] op_sel_hi:[1,1,1]
    v_pk_mul_f32 v[120:121], v[80:81], v[240:241]
    v_pk_mul_f32 v[122:123], v[82:83], v[240:241]
    v_pk_mul_f32 v[124:125], v[84:85], v[240:241]
    v_pk_mul_f32 v[126:127], v[86:87], v[240:241]
    v_pk_mul_f32 v[128:129], v[88:89], v[240:241]
    v_pk_mul_f32 v[130:131], v[90:91], v[240:241]
    v_pk_mul_f32 v[132:133], v[92:93], v[240:241]
    v_pk_mul_f32 v[134:135], v[94:95], v[240:241]
    v_exp_f32 v120, v120
    v_exp_f32 v121, v121
    v_exp_f32 v122, v122
    v_exp_f32 v123, v123
    v_exp_f32 v124, v124
    v_exp_f32 v125, v125
    v_exp_f32 v126, v126
    v_exp_f32 v127, v127
    v_exp_f32 v128, v128
    v_exp_f32 v129, v129
    v_exp_f32 v130, v130
    v_exp_f32 v131, v131
    v_exp_f32 v132, v132
    v_exp_f32 v133, v133
    v_exp_f32 v134, v134
    v_exp_f32 v135, v135
    v_pk_add_f32 v[120:121], v[120:121], v[242:243]
    v_pk_add_f32 v[122:123], v[122:123], v[242:243]
    v_pk_add_f32 v[124:125], v[124:125], v[242:243]
    v_pk_add_f32 v[126:127], v[126:127], v[242:243]
    v_pk_add_f32 v[128:129], v[128:129], v[242:243]
    v_pk_add_f32 v[130:131], v[130:131], v[242:243]
    v_pk_add_f32 v[132:133], v[132:133], v[242:243]
    v_pk_add_f32 v[134:135], v[134:135], v[242:243]
    v_rcp_f32 v120, v120
    v_rcp_f32 v121, v121
    v_rcp_f32 v122, v122
    v_rcp_f32 v123, v123
    v_rcp_f32 v124, v124
    v_rcp_f32 v125, v125
    v_rcp_f32 v126, v126
    v_rcp_f32 v127, v127
    v_rcp_f32 v128, v128
    v_rcp_f32 v129, v129
    v_rcp_f32 v130, v130
    v_rcp_f32 v131, v131
    v_rcp_f32 v132, v132
    v_rcp_f32 v133, v133
    v_rcp_f32 v134, v134
    v_rcp_f32 v135, v135
    v_pk_mul_f32 v[80:81], v[80:81], v[120:121]
    v_pk_mul_f32 v[82:83], v[82:83], v[122:123]
    v_pk_mul_f32 v[84:85], v[84:85], v[124:125]
    v_pk_mul_f32 v[86:87], v[86:87], v[126:127]
    v_pk_mul_f32 v[88:89], v[88:89], v[128:129]
    v_pk_mul_f32 v[90:91], v[90:91], v[130:131]
    v_pk_mul_f32 v[92:93], v[92:93], v[132:133]
    v_pk_mul_f32 v[94:95], v[94:95], v[134:135]
    v_cvt_pk_bf16_f32 v80, v80, v81
    v_cvt_pk_bf16_f32 v81, v82, v83
    v_cvt_pk_bf16_f32 v82, v84, v85
    v_cvt_pk_bf16_f32 v83, v86, v87
    v_cvt_pk_bf16_f32 v84, v88, v89
    v_cvt_pk_bf16_f32 v85, v90, v91
    v_cvt_pk_bf16_f32 v86, v92, v93
    v_cvt_pk_bf16_f32 v87, v94, v95
    v_permlane32_swap_b32 v80, v82
    v_permlane32_swap_b32 v81, v83
    buffer_store_dwordx4 v[80:83], v17, s[52:55], s32 offen offset:3072 sc1
    v_permlane32_swap_b32 v84, v86
    v_permlane32_swap_b32 v85, v87
    buffer_store_dwordx4 v[84:87], v17, s[52:55], s32 offen offset:3584 sc1
    s_waitcnt vmcnt(0)
    s_barrier
    s_cmp_lg_u32 s24, 0
    s_cbranch_scc1 nw0_24
    s_lshl_b32 s45, s28, 2
    s_add_u32 s44, s84, s45
    s_add_u32 s45, s72, 3
    v_mov_b32 v31, s45
    v_mov_b32 v30, 0
    s_mov_b64 exec, 1
    buffer_store_dword v31, v30, s[52:55], s44 offen offset:384 sc1
    s_mov_b64 exec, -1
nw0_24:
    s_cmp_ge_u32 s87, 3
    s_cselect_b32 s79, s86, s35
    s_add_u32 s79, s79, 45056
    buffer_load_dwordx4 v[168:171], v4, s[52:55], s79 offen offset:0 sc1
    buffer_load_dwordx4 v[172:175], v4, s[52:55], s79 offen offset:1024 sc1
    buffer_load_dwordx4 v[176:179], v4, s[52:55], s79 offen offset:2048 sc1
    buffer_load_dwordx4 v[180:183], v4, s[52:55], s79 offen offset:3072 sc1
    s_cmp_ge_u32 s87, 2
    s_cselect_b32 s79, s86, s35
    s_add_u32 s79, s79, 49152
    buffer_load_dwordx4 v[184:187], v4, s[52:55], s79 offen offset:0 sc1
    buffer_load_dwordx4 v[188:191], v4, s[52:55], s79 offen offset:1024 sc1
    buffer_load_dwordx4 v[192:195], v4, s[52:55], s79 offen offset:2048 sc1
    buffer_load_dwordx4 v[196:199], v4, s[52:55], s79 offen offset:3072 sc1
    s_cmp_ge_u32 s87, 1
    s_cselect_b32 s79, s86, s35
    s_add_u32 s79, s79, 53248
    buffer_load_dwordx4 v[200:203], v4, s[52:55], s79 offen offset:0 sc1
    buffer_load_dwordx4 v[204:207], v4, s[52:55], s79 offen offset:1024 sc1
    buffer_load_dwordx4 v[208:211], v4, s[52:55], s79 offen offset:2048 sc1
    buffer_load_dwordx4 v[212:215], v4, s[52:55], s79 offen offset:3072 sc1
    v_add_u32 v5, 57344, v4
    v_add_u32 v6, 114688, v4
    v_add_u32 v7, 172032, v4
    s_mul_i32 s38, s40, 229376
    s_mul_i32 s39, s24, 14336
    s_add_u32 s38, s38, s39
    s_add_u32 s38, s38, 9437184
    s_lshl_b32 s39, s87, 10
    s_add_u32 s38, s38, s39
    s_sub_u32 s37, s38, 14336
    ds_read_b128 v[224:227], v23 offset:3840
    ds_read_b128 v[228:231], v23 offset:3856
    ds_read_b128 v[232:235], v23 offset:3968
    ds_read_b128 v[236:239], v23 offset:3984
    s_waitcnt lgkmcnt(0)
    s_cmp_lg_u32 s24, 0
    s_cbranch_scc1 nw0_25
    s_add_u32 s44, s84, 384
    s_add_u32 s45, s72, 3
    v_lshlrev_b32 v30, 2, v1
    v_cmp_gt_u32 vcc, 14, v1
    s_nop 0
    s_mov_b64 exec, vcc
    s_mov_b32 s47, 0
poll_26:
    buffer_load_dword v31, v30, s[52:55], s44 offen sc1
    s_add_u32 s47, s47, 1
    s_waitcnt vmcnt(0)
    v_cmp_ne_u32 vcc, s45, v31
    s_cmp_gt_u32 s47, 200000
    s_cbranch_scc1 pollx_27
    s_sleep 1
    s_cbranch_vccnz poll_26
pollx_27:
    s_mov_b64 exec, -1
nw0_25:
    s_barrier
    s_lshl_b32 s39, s24, 14
    v_add_u32 v28, s39, v4
p4_loads:
    s_lshl_b32 s39, s24, 12
    v_add_u32 v29, s39, v4
    s_cmp_ge_u32 s87, 14
    s_cselect_b32 s39, s37, s38
    s_add_u32 s39, s39, 0
    buffer_load_dwordx4 a[0:3], v4, s[52:55], s39 offen sc1
    buffer_load_dwordx4 a[4:7], v5, s[52:55], s39 offen sc1
    buffer_load_dwordx4 a[8:11], v6, s[52:55], s39 offen sc1
    buffer_load_dwordx4 a[12:15], v7, s[52:55], s39 offen sc1
    s_cmp_ge_u32 s87, 13
    s_cselect_b32 s39, s37, s38
    s_add_u32 s39, s39, 1024
    buffer_load_dwordx4 a[16:19], v4, s[52:55], s39 offen sc1
    buffer_load_dwordx4 a[20:23], v5, s[52:55], s39 offen sc1
    buffer_load_dwordx4 a[24:27], v6, s[52:55], s39 offen sc1
    buffer_load_dwordx4 a[28:31], v7, s[52:55], s39 offen sc1
    s_cmp_ge_u32 s87, 12
    s_cselect_b32 s39, s37, s38
    s_add_u32 s39, s39, 2048
    buffer_load_dwordx4 a[32:35], v4, s[52:55], s39 offen sc1
    buffer_load_dwordx4 a[36:39], v5, s[52:55], s39 offen sc1
    buffer_load_dwordx4 a[40:43], v6, s[52:55], s39 offen sc1
    buffer_load_dwordx4 a[44:47], v7, s[52:55], s39 offen sc1
    s_waitcnt vmcnt(8)
    v_mfma_f32_16x16x32_bf16 v[32:35], a[112:115], a[0:3], 0
    v_mfma_f32_16x16x32_bf16 v[48:51], a[112:115], a[4:7], 0
    v_mfma_f32_16x16x32_bf16 v[64:67], a[112:115], a[8:11], 0
    v_mfma_f32_16x16x32_bf16 v[80:83], a[112:115], a[12:15], 0
    v_mfma_f32_16x16x32_bf16 v[36:39], a[116:119], a[0:3], 0
    v_mfma_f32_16x16x32_bf16 v[52:55], a[116:119], a[4:7], 0
    v_mfma_f32_16x16x32_bf16 v[68:71], a[116:119], a[8:11], 0
    v_mfma_f32_16x16x32_bf16 v[84:87], a[116:119], a[12:15], 0
    v_mfma_f32_16x16x32_bf16 v[40:43], a[120:123], a[0:3], 0
    v_mfma_f32_16x16x32_bf16 v[56:59], a[120:123], a[4:7], 0
    v_mfma_f32_16x16x32_bf16 v[72:75], a[120:123], a[8:11], 0
    v_mfma_f32_16x16x32_bf16 v[88:91], a[120:123], a[12:15], 0
    v_mfma_f32_16x16x32_bf16 v[44:47], a[124:127], a[0:3], 0
    v_mfma_f32_16x16x32_bf16 v[60:63], a[124:127], a[4:7], 0
    v_mfma_f32_16x16x32_bf16 v[76:79], a[124:127], a[8:11], 0
    v_mfma_f32_16x16x32_bf16 v[92:95], a[124:127], a[12:15], 0
    s_cmp_ge_u32 s87, 11
    s_cselect_b32 s39, s37, s38
    s_add_u32 s39, s39, 3072
    buffer_load_dwordx4 a[0:3], v4, s[52:55], s39 offen sc1
    buffer_load_dwordx4 a[4:7], v5, s[52:55], s39 offen sc1
    buffer_load_dwordx4 a[8:11], v6, s[52:55], s39 offen sc1
    buffer_load_dwordx4 a[12:15], v7, s[52:55], s39 offen sc1
    s_waitcnt vmcnt(8)
    v_mfma_f32_16x16x32_bf16 v[32:35], a[128:131], a[16:19], v[32:35]
    v_mfma_f32_16x16x32_bf16 v[48:51], a[128:131], a[20:23], v[48:51]
    v_mfma_f32_16x16x32_bf16 v[64:67], a[128:131], a[24:27], v[64:67]
    v_mfma_f32_16x16x32_bf16 v[80:83], a[128:131], a[28:31], v[80:83]
    v_mfma_f32_16x16x32_bf16 v[36:39], a[132:135], a[16:19], v[36:39]
    v_mfma_f32_16x16x32_bf16 v[52:55], a[132:135], a[20:23], v[52:55]
    v_mfma_f32_16x16x32_bf16 v[68:71], a[132:135], a[24:27], v[68:71]
    v_mfma_f32_16x16x32_bf16 v[84:87], a[132:135], a[28:31], v[84:87]
    v_mfma_f32_16x16x32_bf16 v[40:43], a[136:139], a[16:19], v[40:43]
    v_mfma_f32_16x16x32_bf16 v[56:59], a[136:139], a[20:23], v[56:59]
    v_mfma_f32_16x16x32_bf16 v[72:75], a[136:139], a[24:27], v[72:75]
    v_mfma_f32_16x16x32_bf16 v[88:91], a[136:139], a[28:31], v[88:91]
    v_mfma_f32_16x16x32_bf16 v[44:47], a[140:143], a[16:19], v[44:47]
    v_mfma_f32_16x16x32_bf16 v[60:63], a[140:143], a[20:23], v[60:63]
    v_mfma_f32_16x16x32_bf16 v[76:79], a[140:143], a[24:27], v[76:79]
    v_mfma_f32_16x16x32_bf16 v[92:95], a[140:143], a[28:31], v[92:95]
    s_cmp_ge_u32 s87, 10
    s_cselect_b32 s39, s37, s38
    s_add_u32 s39, s39, 4096
    buffer_load_dwordx4 a[16:19], v4, s[52:55], s39 offen sc1
    buffer_load_dwordx4 a[20:23], v5, s[52:55], s39 offen sc1
    buffer_load_dwordx4 a[24:27], v6, s[52:55], s39 offen sc1
    buffer_load_dwordx4 a[28:31], v7, s[52:55], s39 offen sc1
    s_waitcnt vmcnt(8)
    v_mfma_f32_16x16x32_bf16 v[32:35], a[144:147], a[32:35], v[32:35]
    v_mfma_f32_16x16x32_bf16 v[48:51], a[144:147], a[36:39], v[48:51]
    v_mfma_f32_16x16x32_bf16 v[64:67], a[144:147], a[40:43], v[64:67]
    v_mfma_f32_16x16x32_bf16 v[80:83], a[144:147], a[44:47], v[80:83]
    v_mfma_f32_16x16x32_bf16 v[36:39], a[148:151], a[32:35], v[36:39]
    v_mfma_f32_16x16x32_bf16 v[52:55], a[148:151], a[36:39], v[52:55]
    v_mfma_f32_16x16x32_bf16 v[68:71], a[148:151], a[40:43], v[68:71]
    v_mfma_f32_16x16x32_bf16 v[84:87], a[148:151], a[44:47], v[84:87]
    v_mfma_f32_16x16x32_bf16 v[40:43], a[152:155], a[32:35], v[40:43]
    v_mfma_f32_16x16x32_bf16 v[56:59], a[152:155], a[36:39], v[56:59]
    v_mfma_f32_16x16x32_bf16 v[72:75], a[152:155], a[40:43], v[72:75]
    v_mfma_f32_16x16x32_bf16 v[88:91], a[152:155], a[44:47], v[88:91]
    v_mfma_f32_16x16x32_bf16 v[44:47], a[156:159], a[32:35], v[44:47]
    v_mfma_f32_16x16x32_bf16 v[60:63], a[156:159], a[36:39], v[60:63]
    v_mfma_f32_16x16x32_bf16 v[76:79], a[156:159], a[40:43], v[76:79]
    v_mfma_f32_16x16x32_bf16 v[92:95], a[156:159], a[44:47], v[92:95]
    s_cmp_ge_u32 s87, 9
    s_cselect_b32 s39, s37, s38
    s_add_u32 s39, s39, 5120
    buffer_load_dwordx4 a[32:35], v4, s[52:55], s39 offen sc1
    buffer_load_dwordx4 a[36:39], v5, s[52:55], s39 offen sc1
    buffer_load_dwordx4 a[40:43], v6, s[52:55], s39 offen sc1
    buffer_load_dwordx4 a[44:47], v7, s[52:55], s39 offen sc1
    s_waitcnt vmcnt(8)
    v_mfma_f32_16x16x32_bf16 v[32:35], a[160:163], a[0:3], v[32:35]
    v_mfma_f32_16x16x32_bf16 v[48:51], a[160:163], a[4:7], v[48:51]
    v_mfma_f32_16x16x32_bf16 v[64:67], a[160:163], a[8:11], v[64:67]
    v_mfma_f32_16x16x32_bf16 v[80:83], a[160:163], a[12:15], v[80:83]
    v_mfma_f32_16x16x32_bf16 v[36:39], a[164:167], a[0:3], v[36:39]
    v_mfma_f32_16x16x32_bf16 v[52:55], a[164:167], a[4:7], v[52:55]
    v_mfma_f32_16x16x32_bf16 v[68:71], a[164:167], a[8:11], v[68:71]
    v_mfma_f32_16x16x32_bf16 v[84:87], a[164:167], a[12:15], v[84:87]
    v_mfma_f32_16x16x32_bf16 v[40:43], a[168:171], a[0:3], v[40:43]
    v_mfma_f32_16x16x32_bf16 v[56:59], a[168:171], a[4:7], v[56:59]
    v_mfma_f32_16x16x32_bf16 v[72:75], a[168:171], a[8:11], v[72:75]
    v_mfma_f32_16x16x32_bf16 v[88:91], a[168:171], a[12:15], v[88:91]
    v_mfma_f32_16x16x32_bf16 v[44:47], a[172:175], a[0:3], v[44:47]
    v_mfma_f32_16x16x32_bf16 v[60:63], a[172:175], a[4:7], v[60:63]
    v_mfma_f32_16x16x32_bf16 v[76:79], a[172:175], a[8:11], v[76:79]
    v_mfma_f32_16x16x32_bf16 v[92:95], a[172:175], a[12:15], v[92:95]
    s_cmp_ge_u32 s87, 8
    s_cselect_b32 s39, s37, s38
    s_add_u32 s39, s39, 6144
    buffer_load_dwordx4 a[0:3], v4, s[52:55], s39 offen sc1
    buffer_load_dwordx4 a[4:7], v5, s[52:55], s39 offen sc1
    buffer_load_dwordx4 a[8:11], v6, s[52:55], s39 offen sc1
    buffer_load_dwordx4 a[12:15], v7, s[52:55], s39 offen sc1
    s_waitcnt vmcnt(8)
    v_mfma_f32_16x16x32_bf16 v[32:35], a[176:179], a[16:19], v[32:35]
    v_mfma_f32_16x16x32_bf16 v[48:51], a[176:179], a[20:23], v[48:51]
    v_mfma_f32_16x16x32_bf16 v[64:67], a[176:179], a[24:27], v[64:67]
    v_mfma_f32_16x16x32_bf16 v[80:83], a[176:179], a[28:31], v[80:83]
    v_mfma_f32_16x16x32_bf16 v[36:39], a[180:183], a[16:19], v[36:39]
    v_mfma_f32_16x16x32_bf16 v[52:55], a[180:183], a[20:23], v[52:55]
    v_mfma_f32_16x16x32_bf16 v[68:71], a[180:183], a[24:27], v[68:71]
    v_mfma_f32_16x16x32_bf16 v[84:87], a[180:183], a[28:31], v[84:87]
    v_mfma_f32_16x16x32_bf16 v[40:43], a[184:187], a[16:19], v[40:43]
    v_mfma_f32_16x16x32_bf16 v[56:59], a[184:187], a[20:23], v[56:59]
    v_mfma_f32_16x16x32_bf16 v[72:75], a[184:187], a[24:27], v[72:75]
    v_mfma_f32_16x16x32_bf16 v[88:91], a[184:187], a[28:31], v[88:91]
    v_mfma_f32_16x16x32_bf16 v[44:47], a[188:191], a[16:19], v[44:47]
    v_mfma_f32_16x16x32_bf16 v[60:63], a[188:191], a[20:23], v[60:63]
    v_mfma_f32_16x16x32_bf16 v[76:79], a[188:191], a[24:27], v[76:79]
    v_mfma_f32_16x16x32_bf16 v[92:95], a[188:191], a[28:31], v[92:95]
    s_cmp_ge_u32 s87, 7
    s_cselect_b32 s39, s37, s38
    s_add_u32 s39, s39, 7168
    buffer_load_dwordx4 a[16:19], v4, s[52:55], s39 offen sc1
    buffer_load_dwordx4 a[20:23], v5, s[52:55], s39 offen sc1
    buffer_load_dwordx4 a[24:27], v6, s[52:55], s39 offen sc1
    buffer_load_dwordx4 a[28:31], v7, s[52:55], s39 offen sc1
    s_waitcnt vmcnt(8)
    v_mfma_f32_16x16x32_bf16 v[32:35], a[192:195], a[32:35], v[32:35]
    v_mfma_f32_16x16x32_bf16 v[48:51], a[192:195], a[36:39], v[48:51]
    v_mfma_f32_16x16x32_bf16 v[64:67], a[192:195], a[40:43], v[64:67]
    v_mfma_f32_16x16x32_bf16 v[80:83], a[192:195], a[44:47], v[80:83]
    v_mfma_f32_16x16x32_bf16 v[36:39], a[196:199], a[32:35], v[36:39]
    v_mfma_f32_16x16x32_bf16 v[52:55], a[196:199], a[36:39], v[52:55]
    v_mfma_f32_16x16x32_bf16 v[68:71], a[196:199], a[40:43], v[68:71]
    v_mfma_f32_16x16x32_bf16 v[84:87], a[196:199], a[44:47], v[84:87]
    v_mfma_f32_16x16x32_bf16 v[40:43], a[200:203], a[32:35], v[40:43]
    v_mfma_f32_16x16x32_bf16 v[56:59], a[200:203], a[36:39], v[56:59]
    v_mfma_f32_16x16x32_bf16 v[72:75], a[200:203], a[40:43], v[72:75]
    v_mfma_f32_16x16x32_bf16 v[88:91], a[200:203], a[44:47], v[88:91]
    v_mfma_f32_16x16x32_bf16 v[44:47], a[204:207], a[32:35], v[44:47]
    v_mfma_f32_16x16x32_bf16 v[60:63], a[204:207], a[36:39], v[60:63]
    v_mfma_f32_16x16x32_bf16 v[76:79], a[204:207], a[40:43], v[76:79]
    v_mfma_f32_16x16x32_bf16 v[92:95], a[204:207], a[44:47], v[92:95]
    s_cmp_ge_u32 s87, 6
    s_cselect_b32 s39, s37, s38
    s_add_u32 s39, s39, 8192
    buffer_load_dwordx4 a[32:35], v4, s[52:55], s39 offen sc1
    buffer_load_dwordx4 a[36:39], v5, s[52:55], s39 offen sc1
    buffer_load_dwordx4 a[40:43], v6, s[52:55], s39 offen sc1
    buffer_load_dwordx4 a[44:47], v7, s[52:55], s39 offen sc1
    s_waitcnt vmcnt(8)
    v_mfma_f32_16x16x32_bf16 v[32:35], a[208:211], a[0:3], v[32:35]
    v_mfma_f32_16x16x32_bf16 v[48:51], a[208:211], a[4:7], v[48:51]
    v_mfma_f32_16x16x32_bf16 v[64:67], a[208:211], a[8:11], v[64:67]
    v_mfma_f32_16x16x32_bf16 v[80:83], a[208:211], a[12:15], v[80:83]
    v_mfma_f32_16x16x32_bf16 v[36:39], a[212:215], a[0:3], v[36:39]
    v_mfma_f32_16x16x32_bf16 v[52:55], a[212:215], a[4:7], v[52:55]
    v_mfma_f32_16x16x32_bf16 v[68:71], a[212:215], a[8:11], v[68:71]
    v_mfma_f32_16x16x32_bf16 v[84:87], a[212:215], a[12:15], v[84:87]
    v_mfma_f32_16x16x32_bf16 v[40:43], a[216:219], a[0:3], v[40:43]
    v_mfma_f32_16x16x32_bf16 v[56:59], a[216:219], a[4:7], v[56:59]
    v_mfma_f32_16x16x32_bf16 v[72:75], a[216:219], a[8:11], v[72:75]
    v_mfma_f32_16x16x32_bf16 v[88:91], a[216:219], a[12:15], v[88:91]
    v_mfma_f32_16x16x32_bf16 v[44:47], a[220:223], a[0:3], v[44:47]
    v_mfma_f32_16x16x32_bf16 v[60:63], a[220:223], a[4:7], v[60:63]
    v_mfma_f32_16x16x32_bf16 v[76:79], a[220:223], a[8:11], v[76:79]
    v_mfma_f32_16x16x32_bf16 v[92:95], a[220:223], a[12:15], v[92:95]
    s_cmp_ge_u32 s87, 5
    s_cselect_b32 s39, s37, s38
    s_add_u32 s39, s39, 9216
    buffer_load_dwordx4 a[0:3], v4, s[52:55], s39 offen sc1
    buffer_load_dwordx4 a[4:7], v5, s[52:55], s39 offen sc1
    buffer_load_dwordx4 a[8:11], v6, s[52:55], s39 offen sc1
    buffer_load_dwordx4 a[12:15], v7, s[52:55], s39 offen sc1
    s_waitcnt vmcnt(8)
    v_mfma_f32_16x16x32_bf16 v[32:35], a[224:227], a[16:19], v[32:35]
    v_mfma_f32_16x16x32_bf16 v[48:51], a[224:227], a[20:23], v[48:51]
    v_mfma_f32_16x16x32_bf16 v[64:67], a[224:227], a[24:27], v[64:67]
    v_mfma_f32_16x16x32_bf16 v[80:83], a[224:227], a[28:31], v[80:83]
    v_mfma_f32_16x16x32_bf16 v[36:39], a[228:231], a[16:19], v[36:39]
    v_mfma_f32_16x16x32_bf16 v[52:55], a[228:231], a[20:23], v[52:55]
    v_mfma_f32_16x16x32_bf16 v[68:71], a[228:231], a[24:27], v[68:71]
    v_mfma_f32_16x16x32_bf16 v[84:87], a[228:231], a[28:31], v[84:87]
    v_mfma_f32_16x16x32_bf16 v[40:43], a[232:235], a[16:19], v[40:43]
    v_mfma_f32_16x16x32_bf16 v[56:59], a[232:235], a[20:23], v[56:59]
    v_mfma_f32_16x16x32_bf16 v[72:75], a[232:235], a[24:27], v[72:75]
    v_mfma_f32_16x16x32_bf16 v[88:91], a[232:235], a[28:31], v[88:91]
    v_mfma_f32_16x16x32_bf16 v[44:47], a[236:239], a[16:19], v[44:47]
    v_mfma_f32_16x16x32_bf16 v[60:63], a[236:239], a[20:23], v[60:63]
    v_mfma_f32_16x16x32_bf16 v[76:79], a[236:239], a[24:27], v[76:79]
    v_mfma_f32_16x16x32_bf16 v[92:95], a[236:239], a[28:31], v[92:95]
    s_cmp_ge_u32 s87, 4
    s_cselect_b32 s39, s37, s38
    s_add_u32 s39, s39, 10240
    buffer_load_dwordx4 a[16:19], v4, s[52:55], s39 offen sc1
    buffer_load_dwordx4 a[20:23], v5, s[52:55], s39 offen sc1
    buffer_load_dwordx4 a[24:27], v6, s[52:55], s39 offen sc1
    buffer_load_dwordx4 a[28:31], v7, s[52:55], s39 offen sc1
    s_waitcnt vmcnt(8)
    v_mfma_f32_16x16x32_bf16 v[32:35], a[240:243], a[32:35], v[32:35]
    v_mfma_f32_16x16x32_bf16 v[48:51], a[240:243], a[36:39], v[48:51]
    v_mfma_f32_16x16x32_bf16 v[64:67], a[240:243], a[40:43], v[64:67]
    v_mfma_f32_16x16x32_bf16 v[80:83], a[240:243], a[44:47], v[80:83]
    v_mfma_f32_16x16x32_bf16 v[36:39], a[244:247], a[32:35], v[36:39]
    v_mfma_f32_16x16x32_bf16 v[52:55], a[244:247], a[36:39], v[52:55]
    v_mfma_f32_16x16x32_bf16 v[68:71], a[244:247], a[40:43], v[68:71]
    v_mfma_f32_16x16x32_bf16 v[84:87], a[244:247], a[44:47], v[84:87]
    v_mfma_f32_16x16x32_bf16 v[40:43], a[248:251], a[32:35], v[40:43]
    v_mfma_f32_16x16x32_bf16 v[56:59], a[248:251], a[36:39], v[56:59]
    v_mfma_f32_16x16x32_bf16 v[72:75], a[248:251], a[40:43], v[72:75]
    v_mfma_f32_16x16x32_bf16 v[88:91], a[248:251], a[44:47], v[88:91]
    v_mfma_f32_16x16x32_bf16 v[44:47], a[252:255], a[32:35], v[44:47]
    v_mfma_f32_16x16x32_bf16 v[60:63], a[252:255], a[36:39], v[60:63]
    v_mfma_f32_16x16x32_bf16 v[76:79], a[252:255], a[40:43], v[76:79]
    v_mfma_f32_16x16x32_bf16 v[92:95], a[252:255], a[44:47], v[92:95]
    s_cmp_ge_u32 s87, 3
    s_cselect_b32 s39, s37, s38
    s_add_u32 s39, s39, 11264
    buffer_load_dwordx4 a[32:35], v4, s[52:55], s39 offen sc1
    buffer_load_dwordx4 a[36:39], v5, s[52:55], s39 offen sc1
    buffer_load_dwordx4 a[40:43], v6, s[52:55], s39 offen sc1
    buffer_load_dwordx4 a[44:47], v7, s[52:55], s39 offen sc1
    s_waitcnt vmcnt(8)
    v_mfma_f32_16x16x32_bf16 v[32:35], v[136:139], a[0:3], v[32:35]
    v_mfma_f32_16x16x32_bf16 v[48:51], v[136:139], a[4:7], v[48:51]
    v_mfma_f32_16x16x32_bf16 v[64:67], v[136:139], a[8:11], v[64:67]
    v_mfma_f32_16x16x32_bf16 v[80:83], v[136:139], a[12:15], v[80:83]
    v_mfma_f32_16x16x32_bf16 v[36:39], v[140:143], a[0:3], v[36:39]
    v_mfma_f32_16x16x32_bf16 v[52:55], v[140:143], a[4:7], v[52:55]
    v_mfma_f32_16x16x32_bf16 v[68:71], v[140:143], a[8:11], v[68:71]
    v_mfma_f32_16x16x32_bf16 v[84:87], v[140:143], a[12:15], v[84:87]
    v_mfma_f32_16x16x32_bf16 v[40:43], v[144:147], a[0:3], v[40:43]
    v_mfma_f32_16x16x32_bf16 v[56:59], v[144:147], a[4:7], v[56:59]
    v_mfma_f32_16x16x32_bf16 v[72:75], v[144:147], a[8:11], v[72:75]
    v_mfma_f32_16x16x32_bf16 v[88:91], v[144:147], a[12:15], v[88:91]
    v_mfma_f32_16x16x32_bf16 v[44:47], v[148:151], a[0:3], v[44:47]
    v_mfma_f32_16x16x32_bf16 v[60:63], v[148:151], a[4:7], v[60:63]
    v_mfma_f32_16x16x32_bf16 v[76:79], v[148:151], a[8:11], v[76:79]
    v_mfma_f32_16x16x32_bf16 v[92:95], v[148:151], a[12:15], v[92:95]
    s_cmp_ge_u32 s87, 2
    s_cselect_b32 s39, s37, s38
    s_add_u32 s39, s39, 12288
    buffer_load_dwordx4 a[0:3], v4, s[52:55], s39 offen sc1
    buffer_load_dwordx4 a[4:7], v5, s[52:55], s39 offen sc1
    buffer_load_dwordx4 a[8:11], v6, s[52:55], s39 offen sc1
    buffer_load_dwordx4 a[12:15], v7, s[52:55], s39 offen sc1
    s_waitcnt vmcnt(8)
    v_mfma_f32_16x16x32_bf16 v[32:35], v[152:155], a[16:19], v[32:35]
    v_mfma_f32_16x16x32_bf16 v[48:51], v[152:155], a[20:23], v[48:51]
    v_mfma_f32_16x16x32_bf16 v[64:67], v[152:155], a[24:27], v[64:67]
    v_mfma_f32_16x16x32_bf16 v[80:83], v[152:155], a[28:31], v[80:83]
    v_mfma_f32_16x16x32_bf16 v[36:39], v[156:159], a[16:19], v[36:39]
    v_mfma_f32_16x16x32_bf16 v[52:55], v[156:159], a[20:23], v[52:55]
    v_mfma_f32_16x16x32_bf16 v[68:71], v[156:159], a[24:27], v[68:71]
    v_mfma_f32_16x16x32_bf16 v[84:87], v[156:159], a[28:31], v[84:87]
    v_mfma_f32_16x16x32_bf16 v[40:43], v[160:163], a[16:19], v[40:43]
    v_mfma_f32_16x16x32_bf16 v[56:59], v[160:163], a[20:23], v[56:59]
    v_mfma_f32_16x16x32_bf16 v[72:75], v[160:163], a[24:27], v[72:75]
    v_mfma_f32_16x16x32_bf16 v[88:91], v[160:163], a[28:31], v[88:91]
    v_mfma_f32_16x16x32_bf16 v[44:47], v[164:167], a[16:19], v[44:47]
    v_mfma_f32_16x16x32_bf16 v[60:63], v[164:167], a[20:23], v[60:63]
    v_mfma_f32_16x16x32_bf16 v[76:79], v[164:167], a[24:27], v[76:79]
    v_mfma_f32_16x16x32_bf16 v[92:95], v[164:167], a[28:31], v[92:95]
    s_cmp_ge_u32 s87, 1
    s_cselect_b32 s39, s37, s38
    s_add_u32 s39, s39, 13312
    buffer_load_dwordx4 a[16:19], v4, s[52:55], s39 offen sc1
    buffer_load_dwordx4 a[20:23], v5, s[52:55], s39 offen sc1
    buffer_load_dwordx4 a[24:27], v6, s[52:55], s39 offen sc1
    buffer_load_dwordx4 a[28:31], v7, s[52:55], s39 offen sc1
    s_waitcnt vmcnt(8)
    v_mfma_f32_16x16x32_bf16 v[32:35], v[168:171], a[32:35], v[32:35]
    v_mfma_f32_16x16x32_bf16 v[48:51], v[168:171], a[36:39], v[48:51]
    v_mfma_f32_16x16x32_bf16 v[64:67], v[168:171], a[40:43], v[64:67]
    v_mfma_f32_16x16x32_bf16 v[80:83], v[168:171], a[44:47], v[80:83]
    v_mfma_f32_16x16x32_bf16 v[36:39], v[172:175], a[32:35], v[36:39]
    v_mfma_f32_16x16x32_bf16 v[52:55], v[172:175], a[36:39], v[52:55]
    v_mfma_f32_16x16x32_bf16 v[68:71], v[172:175], a[40:43], v[68:71]
    v_mfma_f32_16x16x32_bf16 v[84:87], v[172:175], a[44:47], v[84:87]
    v_mfma_f32_16x16x32_bf16 v[40:43], v[176:179], a[32:35], v[40:43]
    v_mfma_f32_16x16x32_bf16 v[56:59], v[176:179], a[36:39], v[56:59]
    v_mfma_f32_16x16x32_bf16 v[72:75], v[176:179], a[40:43], v[72:75]
    v_mfma_f32_16x16x32_bf16 v[88:91], v[176:179], a[44:47], v[88:91]
    v_mfma_f32_16x16x32_bf16 v[44:47], v[180:183], a[32:35], v[44:47]
    v_mfma_f32_16x16x32_bf16 v[60:63], v[180:183], a[36:39], v[60:63]
    v_mfma_f32_16x16x32_bf16 v[76:79], v[180:183], a[40:43], v[76:79]
    v_mfma_f32_16x16x32_bf16 v[92:95], v[180:183], a[44:47], v[92:95]
    s_waitcnt vmcnt(4)
    v_mfma_f32_16x16x32_bf16 v[32:35], v[184:187], a[0:3], v[32:35]
    v_mfma_f32_16x16x32_bf16 v[48:51], v[184:187], a[4:7], v[48:51]
    v_mfma_f32_16x16x32_bf16 v[64:67], v[184:187], a[8:11], v[64:67]
    v_mfma_f32_16x16x32_bf16 v[80:83], v[184:187], a[12:15], v[80:83]
    v_mfma_f32_16x16x32_bf16 v[36:39], v[188:191], a[0:3], v[36:39]
    v_mfma_f32_16x16x32_bf16 v[52:55], v[188:191], a[4:7], v[52:55]
    v_mfma_f32_16x16x32_bf16 v[68:71], v[188:191], a[8:11], v[68:71]
    v_mfma_f32_16x16x32_bf16 v[84:87], v[188:191], a[12:15], v[84:87]
    v_mfma_f32_16x16x32_bf16 v[40:43], v[192:195], a[0:3], v[40:43]
    v_mfma_f32_16x16x32_bf16 v[56:59], v[192:195], a[4:7], v[56:59]
    v_mfma_f32_16x16x32_bf16 v[72:75], v[192:195], a[8:11], v[72:75]
    v_mfma_f32_16x16x32_bf16 v[88:91], v[192:195], a[12:15], v[88:91]
    v_mfma_f32_16x16x32_bf16 v[44:47], v[196:199], a[0:3], v[44:47]
    v_mfma_f32_16x16x32_bf16 v[60:63], v[196:199], a[4:7], v[60:63]
    v_mfma_f32_16x16x32_bf16 v[76:79], v[196:199], a[8:11], v[76:79]
    v_mfma_f32_16x16x32_bf16 v[92:95], v[196:199], a[12:15], v[92:95]
    s_waitcnt vmcnt(0)
    v_mfma_f32_16x16x32_bf16 v[32:35], v[200:203], a[16:19], v[32:35]
    v_mfma_f32_16x16x32_bf16 v[48:51], v[200:203], a[20:23], v[48:51]
    v_mfma_f32_16x16x32_bf16 v[64:67], v[200:203], a[24:27], v[64:67]
    v_mfma_f32_16x16x32_bf16 v[80:83], v[200:203], a[28:31], v[80:83]
    v_mfma_f32_16x16x32_bf16 v[36:39], v[204:207], a[16:19], v[36:39]
    s_nop 3
    ds_write_b128 v29, v[32:35] offset:0
    v_mfma_f32_16x16x32_bf16 v[52:55], v[204:207], a[20:23], v[52:55]
    ds_write_b128 v29, v[48:51] offset:16384
    v_mfma_f32_16x16x32_bf16 v[68:71], v[204:207], a[24:27], v[68:71]
    ds_write_b128 v29, v[64:67] offset:32768
    v_mfma_f32_16x16x32_bf16 v[84:87], v[204:207], a[28:31], v[84:87]
    ds_write_b128 v29, v[80:83] offset:49152
    v_mfma_f32_16x16x32_bf16 v[40:43], v[208:211], a[16:19], v[40:43]
    ds_write_b128 v29, v[36:39] offset:1024
    v_mfma_f32_16x16x32_bf16 v[56:59], v[208:211], a[20:23], v[56:59]
    ds_write_b128 v29, v[52:55] offset:17408
    v_mfma_f32_16x16x32_bf16 v[72:75], v[208:211], a[24:27], v[72:75]
    ds_write_b128 v29, v[68:71] offset:33792
    v_mfma_f32_16x16x32_bf16 v[88:91], v[208:211], a[28:31], v[88:91]
    ds_write_b128 v29, v[84:87] offset:50176
    v_mfma_f32_16x16x32_bf16 v[44:47], v[212:215], a[16:19], v[44:47]
    ds_write_b128 v29, v[40:43] offset:2048
    v_mfma_f32_16x16x32_bf16 v[60:63], v[212:215], a[20:23], v[60:63]
    ds_write_b128 v29, v[56:59] offset:18432
    v_mfma_f32_16x16x32_bf16 v[76:79], v[212:215], a[24:27], v[76:79]
    ds_write_b128 v29, v[72:75] offset:34816
    v_mfma_f32_16x16x32_bf16 v[92:95], v[212:215], a[28:31], v[92:95]
    ds_write_b128 v29, v[88:91] offset:51200
    s_nop 0
    ds_write_b128 v29, v[44:47] offset:3072
    s_nop 0
    ds_write_b128 v29, v[60:63] offset:19456
    s_nop 0
    ds_write_b128 v29, v[76:79] offset:35840
    s_waitcnt lgkmcnt(10)
    ds_write_b128 v29, v[92:95] offset:52224
    s_waitcnt lgkmcnt(0)
    s_barrier
    ds_read_b128 v[32:35], v28 offset:0
    ds_read_b128 v[36:39], v28 offset:1024
    ds_read_b128 v[40:43], v28 offset:2048
    ds_read_b128 v[44:47], v28 offset:3072
    ds_read_b128 v[48:51], v28 offset:4096
    ds_read_b128 v[52:55], v28 offset:5120
    ds_read_b128 v[56:59], v28 offset:6144
    ds_read_b128 v[60:63], v28 offset:7168
    ds_read_b128 v[64:67], v28 offset:8192
    ds_read_b128 v[68:71], v28 offset:9216
    ds_read_b128 v[72:75], v28 offset:10240
    ds_read_b128 v[76:79], v28 offset:11264
    s_waitcnt lgkmcnt(8)
    ds_read_b128 v[80:83], v28 offset:12288
    ds_read_b128 v[84:87], v28 offset:13312
    ds_read_b128 v[88:91], v28 offset:14336
    ds_read_b128 v[92:95], v28 offset:15360
    v_lshlrev_b32 v112, 16, v248
    v_and_b32 v113, 0xffff0000, v248
    v_lshlrev_b32 v114, 16, v249
    v_and_b32 v115, 0xffff0000, v249
    v_lshlrev_b32 v116, 16, v250
    v_and_b32 v117, 0xffff0000, v250
    v_lshlrev_b32 v118, 16, v251
    v_and_b32 v119, 0xffff0000, v251
    v_lshlrev_b32 v120, 16, v252
    v_and_b32 v121, 0xffff0000, v252
    v_lshlrev_b32 v122, 16, v253
    v_and_b32 v123, 0xffff0000, v253
    v_lshlrev_b32 v124, 16, v254
    v_and_b32 v125, 0xffff0000, v254
    v_lshlrev_b32 v126, 16, v255
    v_and_b32 v127, 0xffff0000, v255
    s_waitcnt lgkmcnt(0)
    v_pk_add_f32 v[32:33], v[32:33], v[48:49]
    v_pk_add_f32 v[34:35], v[34:35], v[50:51]
    v_pk_add_f32 v[36:37], v[36:37], v[52:53]
    v_pk_add_f32 v[38:39], v[38:39], v[54:55]
    v_pk_add_f32 v[40:41], v[40:41], v[56:57]
    v_pk_add_f32 v[42:43], v[42:43], v[58:59]
    v_pk_add_f32 v[44:45], v[44:45], v[60:61]
    v_pk_add_f32 v[46:47], v[46:47], v[62:63]
    v_pk_add_f32 v[64:65], v[64:65], v[80:81]
    v_pk_add_f32 v[66:67], v[66:67], v[82:83]
    v_pk_add_f32 v[68:69], v[68:69], v[84:85]
    v_pk_add_f32 v[70:71], v[70:71], v[86:87]
    v_pk_add_f32 v[72:73], v[72:73], v[88:89]
    v_pk_add_f32 v[74:75], v[74:75], v[90:91]
    v_pk_add_f32 v[76:77], v[76:77], v[92:93]
    v_pk_add_f32 v[78:79], v[78:79], v[94:95]
    v_pk_add_f32 v[32:33], v[32:33], v[64:65]
    v_pk_add_f32 v[34:35], v[34:35], v[66:67]
    v_pk_add_f32 v[36:37], v[36:37], v[68:69]
    v_pk_add_f32 v[38:39], v[38:39], v[70:71]
    v_pk_add_f32 v[40:41], v[40:41], v[72:73]
    v_pk_add_f32 v[42:43], v[42:43], v[74:75]
    v_pk_add_f32 v[44:45], v[44:45], v[76:77]
    v_pk_add_f32 v[46:47], v[46:47], v[78:79]
    v_cvt_pk_bf16_f32 v100, v32, v33
    v_cvt_pk_bf16_f32 v101, v34, v35
    v_cvt_pk_bf16_f32 v102, v36, v37
    v_cvt_pk_bf16_f32 v103, v38, v39
    v_cvt_pk_bf16_f32 v104, v40, v41
    v_cvt_pk_bf16_f32 v105, v42, v43
    v_cvt_pk_bf16_f32 v106, v44, v45
    v_cvt_pk_bf16_f32 v107, v46, v47
    v_permlane16_swap_b32 v100, v102
    v_permlane16_swap_b32 v101, v103
    v_permlane16_swap_b32 v104, v106
    v_permlane16_swap_b32 v105, v107
    v_lshlrev_b32 v32, 16, v100
    v_and_b32 v33, 0xffff0000, v100
    v_lshlrev_b32 v34, 16, v101
    v_and_b32 v35, 0xffff0000, v101
    v_lshlrev_b32 v36, 16, v102
    v_and_b32 v37, 0xffff0000, v102
    v_lshlrev_b32 v38, 16, v103
    v_and_b32 v39, 0xffff0000, v103
    v_lshlrev_b32 v40, 16, v104
    v_and_b32 v41, 0xffff0000, v104
    v_lshlrev_b32 v42, 16, v105
    v_and_b32 v43, 0xffff0000, v105
    v_lshlrev_b32 v44, 16, v106
    v_and_b32 v45, 0xffff0000, v106
    v_lshlrev_b32 v46, 16, v107
    v_and_b32 v47, 0xffff0000, v107
    v_pk_mul_f32 v[32:33], v[224:225], v[32:33]
    v_pk_mul_f32 v[34:35], v[226:227], v[34:35]
    v_pk_mul_f32 v[36:37], v[228:229], v[36:37]
    v_pk_mul_f32 v[38:39], v[230:231], v[38:39]
    v_pk_mul_f32 v[40:41], v[232:233], v[40:41]
    v_pk_mul_f32 v[42:43], v[234:235], v[42:43]
    v_pk_mul_f32 v[44:45], v[236:237], v[44:45]
    v_pk_mul_f32 v[46:47], v[238:239], v[46:47]
    v_cvt_pk_bf16_f32 v100, v32, v33
    v_cvt_pk_bf16_f32 v101, v34, v35
    v_cvt_pk_bf16_f32 v102, v36, v37
    v_cvt_pk_bf16_f32 v103, v38, v39
    v_cvt_pk_bf16_f32 v104, v40, v41
    v_cvt_pk_bf16_f32 v105, v42, v43
    v_cvt_pk_bf16_f32 v106, v44, v45
    v_cvt_pk_bf16_f32 v107, v46, v47
    v_lshlrev_b32 v32, 16, v100
    v_and_b32 v33, 0xffff0000, v100
    v_lshlrev_b32 v34, 16, v101
    v_and_b32 v35, 0xffff0000, v101
    v_lshlrev_b32 v36, 16, v102
    v_and_b32 v37, 0xffff0000, v102
    v_lshlrev_b32 v38, 16, v103
    v_and_b32 v39, 0xffff0000, v103
    v_lshlrev_b32 v40, 16, v104
    v_and_b32 v41, 0xffff0000, v104
    v_lshlrev_b32 v42, 16, v105
    v_and_b32 v43, 0xffff0000, v105
    v_lshlrev_b32 v44, 16, v106
    v_and_b32 v45, 0xffff0000, v106
    v_lshlrev_b32 v46, 16, v107
    v_and_b32 v47, 0xffff0000, v107
    v_pk_add_f32 v[32:33], v[112:113], v[32:33]
    v_pk_add_f32 v[34:35], v[114:115], v[34:35]
    v_pk_add_f32 v[36:37], v[116:117], v[36:37]
    v_pk_add_f32 v[38:39], v[118:119], v[38:39]
    v_pk_add_f32 v[40:41], v[120:121], v[40:41]
    v_pk_add_f32 v[42:43], v[122:123], v[42:43]
    v_pk_add_f32 v[44:45], v[124:125], v[44:45]
    v_pk_add_f32 v[46:47], v[126:127], v[46:47]
    v_cvt_pk_bf16_f32 v100, v32, v33
    v_cvt_pk_bf16_f32 v101, v34, v35
    v_cvt_pk_bf16_f32 v102, v36, v37
    v_cvt_pk_bf16_f32 v103, v38, v39
    v_cvt_pk_bf16_f32 v104, v40, v41
    v_cvt_pk_bf16_f32 v105, v42, v43
    v_cvt_pk_bf16_f32 v106, v44, v45
    v_cvt_pk_bf16_f32 v107, v46, v47
    buffer_store_dwordx4 v[100:103], v22, s[68:71], s42 offen nt
    buffer_store_dwordx4 v[104:107], v22, s[68:71], s42 offen offset:64 nt
k_fin:
k_end:
    s_endpgm

.section .rodata,"a"
.p2align 6
.amdhsa_kernel adaLN_cond__sliding_local_dilated__dense_activation_silu__prompt_kernel
  .amdhsa_next_free_vgpr 512
  .amdhsa_next_free_sgpr 102
  .amdhsa_accum_offset 256
  .amdhsa_group_segment_fixed_size 0
  .amdhsa_kernarg_size 88
  .amdhsa_user_sgpr_count 2
  .amdhsa_user_sgpr_kernarg_segment_ptr 1
  .amdhsa_system_sgpr_workgroup_id_x 1
.end_amdhsa_kernel
```
